```python
import torch

def _softmax(x, axis=-1):
    return torch.softmax(x, dim=axis)
def _gelu(x):
    return torch.nn.functional.gelu(x, approximate="tanh")
def _silu(x):
    return torch.nn.functional.silu(x)
def _sigmoid(x):
    return torch.sigmoid(x)
def _layernorm(x, axis=-1, eps=1e-5):
    m = x.mean(dim=axis, keepdim=True)
    v = x.var(dim=axis, keepdim=True, unbiased=False)
    return (x - m) / torch.sqrt(v + eps)
def _scatter_add(tgt, idx, src, axis=0):
    return tgt.clone().index_add_(axis, idx, src)
def _segment_sum(src, seg, n):
    out = torch.zeros((n,) + src.shape[1:], dtype=src.dtype)
    return out.index_add_(0, seg, src)
def _pad(x, pw):
    flat = tuple(v for pair in reversed(pw) for v in pair)
    return torch.nn.functional.pad(x, flat)

kernel_name = 'standalone__adm_resblock__diffusion'

def setup_inputs():

    _w = (lambda a: (lambda t: t.to(torch.bfloat16) if t.is_floating_point() else t)(torch.as_tensor(a)))
    B, C, HW, E = 2, 512, 64, 384
    sc = (9.0 * C) ** -0.5
    return {
        "x": _w((lambda *s: torch.randn(*s, dtype=torch.bfloat16) * 0.05)(B, C, HW, HW)),
        "t_emb": _w((lambda *s: torch.randn(*s, dtype=torch.bfloat16) * 0.2)(B, E)),
        "g1": _w(1.0 + 0.1 * (lambda *s: torch.randn(*s, dtype=torch.bfloat16) * 0.2)(C)),
        "be1": _w(0.1 * (lambda *s: torch.randn(*s, dtype=torch.bfloat16) * 0.2)(C)),
        "w1": _w((lambda *s: torch.randn(*s, dtype=torch.bfloat16) * 0.2)(C, C, 3, 3) * sc),
        "w_emb": _w((lambda *s: torch.randn(*s, dtype=torch.bfloat16) * 0.2)(E, C) * (E ** -0.5)),
        "g2": _w(1.0 + 0.1 * (lambda *s: torch.randn(*s, dtype=torch.bfloat16) * 0.2)(C)),
        "be2": _w(0.1 * (lambda *s: torch.randn(*s, dtype=torch.bfloat16) * 0.2)(C)),
        "w2": _w((lambda *s: torch.randn(*s, dtype=torch.bfloat16) * 0.2)(C, C, 3, 3) * sc),
    }

def reference(x, t_emb, g1, be1, w1, w_emb, g2, be2, w2):
    B, C, H, W = x.shape
    G, eps = 4, 1e-5
    def gn(z, gamma, beta):
        zr = z.reshape(B, G, (C // G) * H * W)
        mu = zr.mean(-1).reshape(B, G, 1)
        var = ((zr - mu) ** 2).mean(-1).reshape(B, G, 1)
        zn = ((zr - mu) / torch.sqrt(var + eps)).reshape(B, C, H, W)
        return zn * gamma.reshape(1, C, 1, 1) + beta.reshape(1, C, 1, 1)
    def conv3(z, w):
        zp = _pad(z, ((0, 0), (0, 0), (1, 1), (1, 1)))
        taps = [torch.einsum("bchw,oc->bohw", zp[:, :, i:i+H, j:j+W], w[:, :, i, j]) for i in range(3) for j in range(3)]
        out = taps[0]
        for t in taps[1:]:
            out = out + t
        return out
    h = conv3(_silu(gn(x, g1, be1)), w1)
    emb = _silu(t_emb) @ w_emb
    h = h + emb.reshape(B, C, 1, 1)
    h = conv3(_silu(gn(h, g2, be2)), w2)
    return x + h
```

```asm
; @launch grid=(256,1,1) block=(256,1,1) lds=162128
.amdgcn_target "amdgcn-amd-amdhsa--gfx950"
.text
.globl standalone__adm_resblock__diffusion_kernel
.p2align 8
.type standalone__adm_resblock__diffusion_kernel,@function
standalone__adm_resblock__diffusion_kernel:
    s_cmp_ge_u32 s2, 256
    s_cbranch_scc1 L_end
    s_load_dwordx16 s[72:87], s[0:1], 0
    s_load_dwordx8 s[88:95], s[0:1], 64
    v_lshrrev_b32 v16, 6, v0
    s_nop 0
    v_readfirstlane_b32 s3, v16
    v_and_b32 v16, 63, v0
    v_lshlrev_b32 v9, 4, v16
    s_lshr_b32 s33, s2, 3
    s_lshl2_add_u32 s39, s33, s3
    s_and_b32 s39, s39, 63
    s_cmp_ge_u32 s39, 39
    s_cselect_b32 s38, 39, 0
    s_sub_u32 s39, s39, s38
    s_lshl_b32 s39, s39, 10
    s_add_u32 s39, s39, L_x-L_pc_a
    s_ashr_i32 s38, s39, 31
    s_getpc_b64 s[98:99]
L_pc_a:
    s_add_u32 s98, s98, s39
    s_addc_u32 s99, s99, s38
    v_add_co_u32 v114, vcc, s98, v9
    v_mov_b32 v115, s99
    s_nop 0
    v_addc_co_u32_e64 v115, vcc, 0, v115, vcc
    global_load_dword v113, v[114:115], off
    s_and_b32 s32, s2, 7
    s_lshr_b32 s34, s32, 2
    s_and_b32 s39, s32, 3
    s_and_b32 s31, s33, 1
    s_lshl1_add_u32 s35, s39, s31
    s_lshr_b32 s36, s33, 1
    s_lshr_b32 s38, s3, 1
    s_xor_b32 s38, s38, 1
    s_lshl1_add_u32 s45, s35, s38
    s_and_b32 s38, s3, 1
    s_mul_i32 s38, s38, 3
    s_lshl2_add_u32 s47, s36, s38
    v_lshrrev_b32 v17, 4, v16
    s_lshl_b32 s38, s45, 7
    v_lshl_add_u32 v12, v17, 5, s38
    v_lshlrev_b32 v17, 11, v12
    v_and_b32 v18, 15, v16
    v_lshl_add_u32 v17, v18, 3, v17
    s_lshl_b32 s38, s34, 22
    s_lshl_b32 s37, s47, 7
    s_add_u32 s37, s37, s38
    v_add_u32 v10, s37, v17
    v_xor_b32 v22, 128, v10
    v_and_b32_e64 v19, 31, v16
    v_lshl_add_u32 v13, v19, 3, s32
    v_lshlrev_b32 v13, 7, v13
    s_lshl_b32 s38, s32, 11
    s_add_u32 s38, s38, 163840
    v_lshl_add_u32 v17, v18, 7, s38
    v_cmp_gt_u32 vcc, 32, v16
    s_nop 1
    v_cndmask_b32 v17, v17, v13, vcc
    s_xor_b32 s71, s3, 1
    s_or_b32 s71, s71, s33
    s_cselect_b32 s37, 360448, 0
    s_add_u32 s37, s37, 32768
    s_mov_b32 s60, 0
    s_mov_b32 s61, 8192
    s_mov_b32 s62, 16384
    s_mov_b32 s63, 24576
    s_mov_b32 s64, 32768
    s_mov_b32 s65, 40960
    s_mov_b32 s66, 49152
    s_mov_b32 s67, 57344
    s_mov_b32 s6, 0x800000
    s_mov_b32 s7, 0x20000
    s_mov_b32 s18, 0x40000
    s_mov_b32 s19, 0x20000
    s_waitcnt lgkmcnt(0)
    s_mov_b64 s[16:17], s[94:95]
    s_mov_b64 s[4:5], s[72:73]
L_x:
    buffer_load_dword v76, v17, s[16:19], s37 offen offset:4 sc1
    s_lshl1_add_u32 s38, s39, s34
    s_lshl4_add_u32 s38, s38, s36
    s_mul_i32 s38, s38, 36864
    v_mov_b32 v116, s38
    s_bitcmp1_b32 s3, 0
    s_cselect_b64 s[98:99], s[88:89], s[80:81]
    global_load_dword v117, v116, s[98:99]
    buffer_load_dwordx2 v[224:225], v10, s[4:7], s60 offen
    buffer_load_dwordx2 v[240:241], v22, s[4:7], s60 offen
    buffer_load_dwordx2 v[226:227], v10, s[4:7], s61 offen
    buffer_load_dwordx2 v[242:243], v22, s[4:7], s61 offen
    buffer_load_dwordx2 v[228:229], v10, s[4:7], s62 offen
    buffer_load_dwordx2 v[244:245], v22, s[4:7], s62 offen
    buffer_load_dwordx2 v[230:231], v10, s[4:7], s63 offen
    buffer_load_dwordx2 v[246:247], v22, s[4:7], s63 offen
    buffer_load_dwordx2 v[232:233], v10, s[4:7], s64 offen
    buffer_load_dwordx2 v[248:249], v22, s[4:7], s64 offen
    buffer_load_dwordx2 v[234:235], v10, s[4:7], s65 offen
    buffer_load_dwordx2 v[250:251], v22, s[4:7], s65 offen
    buffer_load_dwordx2 v[236:237], v10, s[4:7], s66 offen
    buffer_load_dwordx2 v[252:253], v22, s[4:7], s66 offen
    buffer_load_dwordx2 v[238:239], v10, s[4:7], s67 offen
    buffer_load_dwordx2 v[254:255], v22, s[4:7], s67 offen
    s_bitcmp1_b32 s3, 0
    s_cselect_b64 s[48:49], s[78:79], s[76:77]
    s_cselect_b64 s[50:51], s[86:87], s[84:85]
    s_cselect_b32 s37, 1024, 0
    s_bitcmp1_b32 s3, 1
    s_cselect_b64 s[48:49], s[50:51], s[48:49]
    s_cselect_b32 s38, 110928, 0
    s_add_u32 s37, s37, s38
    s_add_u32 m0, s37, 49152
    s_mov_b32 s50, 1024
    s_mov_b32 s51, 0x20000
    buffer_load_dwordx4 v9, s[48:51], 0 offen lds
    s_cmp_lg_u32 s3, 3
    s_cbranch_scc1 L_else1
    s_mov_b64 s[8:9], s[82:83]
    s_mov_b32 s10, 0x60000
    s_mov_b32 s11, 0x20000
    s_mov_b64 s[4:5], s[74:75]
    s_mov_b32 s6, 0x600
    s_mov_b32 s7, 0x20000
    v_lshrrev_b32 v18, 3, v16
    s_mul_i32 s37, s36, 24
    v_add_u32 v18, s37, v18
    v_lshlrev_b32 v17, 10, v18
    v_and_b32_e64 v21, 7, v16
    v_lshl_add_u32 v17, v21, 4, v17
    s_lshl_b32 s37, s35, 7
    v_add_u32 v17, s37, v17
    v_lshlrev_b32_e64 v18, 1, v18
    s_mul_i32 s37, s34, 768
    buffer_load_dwordx4 v[128:131], v17, s[8:11], s60 offen
    buffer_load_ushort v140, v18, s[4:7], s37 offen offset:0
    buffer_load_dwordx4 v[132:135], v17, s[8:11], s61 offen
    buffer_load_ushort v141, v18, s[4:7], s37 offen offset:16
    buffer_load_dwordx4 v[136:139], v17, s[8:11], s62 offen
    buffer_load_ushort v142, v18, s[4:7], s37 offen offset:32
L_else1:
    v_mov_b32 v64, 0
    v_mov_b32 v65, 0
    v_mov_b32 v66, 0
    v_mov_b32 v67, 0
    v_mov_b32 v68, 0
    v_mov_b32 v69, 0
    v_mov_b32 v70, 0
    v_mov_b32 v71, 0
    s_lshl1_add_u32 s69, s39, s34
    s_lshl4_add_u32 s68, s69, s36
    s_lshl2_add_u32 s37, s68, s3
    s_mul_i32 s70, s37, 9216
    s_mul_i32 s37, s3, 9280
    s_add_u32 s96, s37, 122880
    s_lshl_b32 s37, s32, 5
    v_mov_b32 v75, s37
    s_mov_b64 s[20:21], s[80:81]
    s_mov_b32 s22, 0x480000
    s_mov_b32 s23, 0x20000
    s_add_u32 m0, s96, 0
    s_add_u32 s97, s70, 0
    buffer_load_dwordx4 v9, s[20:23], s97 offen offset:0 lds
    buffer_load_dwordx4 v9, s[20:23], s97 offen offset:1024 lds
    buffer_load_dwordx4 v9, s[20:23], s97 offen offset:2048 lds
    s_lshl_b32 s37, s3, 2
    s_lshr_b32 s38, 0x247b, s37
    s_and_b32 s38, s38, 15
    s_lshl_b32 s38, s38, 13
    s_add_u32 s25, s38, 24576
    s_lshr_b32 s38, 0x3196, s37
    s_and_b32 s38, s38, 15
    s_lshl_b32 s38, s38, 13
    s_add_u32 s26, s38, 24576
    s_lshr_b32 s38, 0x8a05, s37
    s_and_b32 s38, s38, 15
    v_mfma_f32_32x32x16_f16 a[0:15], v[64:67], v[64:67], 0
    s_lshl_b32 s38, s38, 13
    s_add_u32 s27, s38, 24576
    s_mul_i32 s38, s3, 24576
    s_add_u32 s28, s38, 24576
    s_lshl_b32 s38, s3, 10
    s_add_u32 s24, s38, 122880
    s_lshl4_add_u32 s38, s34, s45
    s_lshl_b32 s38, s38, 18
    s_lshl_b32 s37, s47, 12
    s_add_u32 s29, s37, s38
    v_mfma_f32_32x32x16_f16 a[16:31], v[64:67], v[64:67], 0
    s_xor_b32 s30, s29, 4096
    s_bitcmp1_b32 s3, 0
    s_cselect_b32 s54, -1.0, 1.0
    s_cmp_eq_u32 s3, 0
    s_cselect_b32 s55, -1.0, 1.0
    s_add_u32 s38, s3, 1
    s_bitcmp1_b32 s38, 1
    s_cselect_b32 s56, 0, 1.0
    s_cselect_b32 s57, s54, 0
    s_xor_b32 s57, s57, 0x80000000
    s_mov_b32 s37, 0xbc00bc00
    v_mfma_f32_32x32x16_f16 a[32:47], v[64:67], v[64:67], 0
    s_cmp_eq_u32 s3, 1
    s_cselect_b32 s42, 0x3c003c00, s37
    s_mul_i32 s43, s3, 6144
    s_lshl_b32 s68, s68, 4
    s_xor_b32 s37, s3, 1
    s_or_b32 s37, s37, s31
    s_cselect_b32 s68, 393216, s68
    s_bfe_u32 s37, s36, 0x20001
    s_lshl_b32 s37, s37, 8
    s_and_b32 s38, s36, 1
    v_mfma_f32_32x32x16_f16 a[48:63], v[64:67], v[64:67], 0
    s_mul_i32 s38, s38, 12288
    s_add_u32 s46, s37, s38
    s_mul_i32 s37, s3, 49152
    s_add_u32 s46, s46, s37
    s_lshr_b32 s38, s36, 3
    s_xor_b32 s38, s38, s31
    s_mul_i32 s38, s38, 24576
    s_mul_i32 s37, s31, 9216
    s_add_u32 s58, s38, s37
    s_mul_i32 s37, s31, 3072
    s_add_u32 s59, s38, s37
    v_mfma_f32_32x32x16_f16 a[64:79], v[64:67], v[64:67], 0
    s_add_u32 s59, s59, 3072
    s_mul_i32 s37, s39, 0x2222220
    s_add_u32 s37, s37, 0x7654320
    s_and_b32 s37, s37, 0x7777770
    s_xor_b32 s38, s35, 1
    s_or_b32 s37, s37, s38
    s_or_b32 s87, s37, 0xf0000000
    s_lshl2_add_u32 s38, s31, s39
    v_lshl_add_u32 v17, v19, 3, s38
    v_lshlrev_b32 v17, 7, v17
    v_mfma_f32_32x32x16_f16 a[80:95], v[64:67], v[64:67], 0
    s_xor_b32 s38, s38, 4
    s_lshl_b32 s0, 0x01010101, s38
    s_mov_b32 s1, 0
    v_mov_b32 v21, v17
    s_and_b32 s38, s2, 15
    v_and_b32_e64 v18, 15, v16
    v_lshl_add_u32 v18, v18, 4, s38
    v_lshlrev_b32 v18, 7, v18
    v_cmp_gt_u32 vcc, 32, v16
    s_nop 1
    v_cndmask_b32 v11, v18, v17, vcc
    v_lshrrev_b32_e64 v17, 3, v16
    v_mfma_f32_32x32x16_f16 a[96:111], v[64:67], v[64:67], 0
    v_min_u32 v17, 2, v17
    s_add_i32 s38, s36, -1
    v_add_u32_e64 v17, s38, v17
    v_med3_i32 v17, v17, 0, 15
    v_lshlrev_b32 v17, 4, v17
    v_and_b32 v18, 4, v16
    v_lshl_add_u32 v17, v18, 1, v17
    v_and_b32 v18, 3, v16
    s_lshl_b32 s38, s34, 2
    v_add3_u32 v17, v17, v18, s38
    s_cmp_lg_u32 s71, 0
    s_cbranch_scc1 L_else2
    s_waitcnt vmcnt(21)
    v_cmp_le_i32 s[98:99], 0, v76
    v_mov_b32 v78, 1
    v_mov_b32 v79, 0
    v_mov_b32 v76, s98
    v_mov_b32 v77, 0
    s_mov_b64 exec, 1
    global_store_dwordx4 v75, v[76:79], s[92:93] sc1
    s_mov_b64 exec, -1
L_else2:
    buffer_load_dwordx4 v9, s[20:23], s97 offen offset:3072 lds
    v_mfma_f32_32x32x16_f16 a[112:127], v[64:67], v[64:67], 0
    v_lshlrev_b32 v14, 7, v17
    v_cndmask_b32_e64 v14, v21, v14, vcc
    s_mul_i32 s37, s3, 3072
    v_add_u32 v1, s37, v9
    s_lshl_b32 s37, s36, 14
    s_add_u32 s37, s37, s43
    s_lshl2_add_u32 s38, s36, s3
    s_cmp_eq_u32 s38, 0
    s_cselect_b32 s39, 0x80000000, s37
    v_add_u32 v2, s39, v9
    v_mfma_f32_32x32x16_f16 a[128:143], v[64:67], v[64:67], 0
    s_add_u32 s37, s37, 4096
    s_cmp_eq_u32 s38, 63
    s_cselect_b32 s39, 0x80000000, s39
    s_cselect_b32 s37, 0x80000000, s37
    v_add_u32 v3, s39, v9
    v_add_u32 v4, s37, v9
    s_and_b32 s38, s3, 1
    s_add_u32 m0, s96, 4096
    s_add_u32 s97, s70, 4096
    buffer_load_dwordx4 v9, s[20:23], s97 offen offset:0 lds
    s_lshl_b32 s38, s38, 13
    s_xor_b32 s37, s38, 8192
    s_lshl_b32 s39, s3, 12
    v_add_u32_e64 v17, s39, v9
    v_mfma_f32_32x32x16_f16 a[144:159], v[64:67], v[64:67], 0
    v_add_u32 v5, s37, v17
    v_add_u32 v6, s38, v17
    s_lshr_b32 s39, s3, 1
    s_sub_u32 s39, 2, s39
    s_lshl_b32 s39, s39, 12
    v_add_u32 v17, s39, v9
    v_add_u32 v7, s37, v17
    v_add_u32 v8, s38, v17
    v_and_b32 v17, 0xc0, v9
    v_and_b32_e64 v18, 48, v9
    v_mfma_f32_32x32x16_f16 a[160:175], v[64:67], v[64:67], 0
    v_lshl_add_u32 v17, v17, 2, v18
    v_lshrrev_b32_e64 v18, 8, v9
    buffer_load_dwordx4 v9, s[20:23], s97 offen offset:1024 lds
    v_lshl_add_u32 v17, v18, 6, v17
    s_mul_i32 s37, s3, 3072
    v_add_u32_e64 v1, s37, v17
    s_mul_i32 s40, s35, 98304
    s_lshl_b32 s41, s35, 19
    s_mov_b32 s85, s87
    s_mov_b32 s44, 0
    s_mov_b32 s84, 0
    v_lshrrev_b32_e64 v148, 8, v9
    v_mfma_f32_32x32x16_f16 a[176:191], v[64:67], v[64:67], 0
    v_mul_u32_u24 v148, 196608, v148
    v_and_b32 v18, 0xf0, v9
    v_add3_u32 v148, v148, v18, s46
    s_mul_i32 s37, s69, 786432
    s_add_u32 s48, s37, 0x1300000
    s_add_u32 s48, s94, s48
    s_addc_u32 s49, s95, 0
    s_mov_b32 s50, 0xc0000
    buffer_load_dwordx4 v9, s[20:23], s97 offen offset:2048 lds
    s_mov_b32 s51, 0x20000
    s_mul_i32 s37, s35, 786432
    v_mfma_f32_32x32x16_f16 a[192:207], v[64:67], v[64:67], 0
    s_add_u32 s4, s37, 0x1300000
    s_add_u32 s4, s94, s4
    s_addc_u32 s5, s95, 0
    s_mov_b32 s6, 0xc0000
    s_mov_b32 s7, 0x20000
    s_add_u32 s12, s94, 0x100000
    s_addc_u32 s13, s95, 0
    s_mov_b32 s14, 0x800000
    s_mov_b32 s15, 0x20000
    s_lshl_b32 s37, s34, 22
    s_add_u32 s8, s37, 0xff000
    v_mfma_f32_32x32x16_f16 a[208:223], v[64:67], v[64:67], 0
    s_add_u32 s8, s94, s8
    s_addc_u32 s9, s95, 0
    s_mov_b32 s10, 0x401000
    s_mov_b32 s11, 0x20000
    buffer_load_dwordx4 v9, s[20:23], s97 offen offset:3072 lds
    s_lshr_b32 s37, s3, 1
    s_mul_i32 s37, s37, 24576
    s_and_b32 s38, s3, 1
    s_mul_i32 s39, s38, 12288
    s_add_u32 s39, s39, s37
    s_add_u32 s78, s39, 4096
    v_mfma_f32_32x32x16_f16 a[224:239], v[64:67], v[64:67], 0
    s_lshl_b32 s38, s38, 12
    s_add_u32 s38, s38, s37
    s_add_u32 s79, s38, 8192
    s_lshl4_add_u32 s37, s36, s3
    s_lshl_b32 s37, s37, 10
    s_cmp_eq_u32 s36, 0
    s_cselect_b32 s83, 0x80000000, s37
    s_add_u32 s37, s37, 20480
    s_cmp_eq_u32 s36, 15
    s_nop 0
    s_cselect_b32 s69, 0x80000000, s37
    v_mfma_f32_32x32x16_f16 a[240:255], v[64:67], v[64:67], 0
    s_add_u32 m0, s96, 8192
    s_add_u32 s97, s70, 8192
    buffer_load_dwordx4 v9, s[20:23], s97 offen offset:0 lds
    s_lshl_b32 s37, s2, 7
    s_add_u32 s37, s37, 32768
    s_cmp_eq_u32 s3, 0
    s_cselect_b32 s71, s37, 393216
    s_cselect_b32 s45, 0, 360448
    s_add_u32 s45, s45, 32768
    s_mov_b64 s[20:21], s[88:89]
    s_sub_u32 s96, s96, 71680
    s_mov_b32 s88, 0xffff0000
    s_branch L_p1
.p2alignl 12, 0xbf810000
.fill 498, 4, 0xbf810000
L_p1:
    s_waitcnt vmcnt(22)
    v_lshlrev_b32 v80, 16, v224
    v_and_b32 v88, s88, v224
    v_lshlrev_b32 v96, 16, v225
    v_and_b32 v104, s88, v225
    v_lshlrev_b32 v176, 16, v240
    v_and_b32 v184, s88, v240
    v_lshlrev_b32 v192, 16, v241
    v_and_b32 v200, s88, v241
    v_lshlrev_b32 v81, 16, v226
    v_and_b32 v89, s88, v226
    v_lshlrev_b32 v97, 16, v227
    v_and_b32 v105, s88, v227
    v_lshlrev_b32 v177, 16, v242
    v_and_b32 v185, s88, v242
    v_lshlrev_b32 v193, 16, v243
    v_and_b32_e64 v201, s88, v243
    v_pk_add_f32 v[64:65], v[64:65], v[80:81]
    v_pk_fma_f32 v[68:69], v[80:81], v[80:81], v[68:69]
    v_pk_add_f32 v[66:67], v[66:67], v[88:89]
    v_pk_fma_f32 v[70:71], v[88:89], v[88:89], v[70:71]
    v_pk_add_f32 v[64:65], v[64:65], v[96:97]
    v_pk_fma_f32 v[68:69], v[96:97], v[96:97], v[68:69]
    v_pk_add_f32 v[66:67], v[66:67], v[104:105]
    v_pk_fma_f32 v[70:71], v[104:105], v[104:105], v[70:71]
    v_pk_add_f32 v[64:65], v[64:65], v[176:177]
    v_pk_fma_f32 v[68:69], v[176:177], v[176:177], v[68:69]
    v_pk_add_f32 v[66:67], v[66:67], v[184:185]
    v_pk_fma_f32 v[70:71], v[184:185], v[184:185], v[70:71]
    v_pk_add_f32 v[64:65], v[64:65], v[192:193]
    v_pk_fma_f32 v[68:69], v[192:193], v[192:193], v[68:69]
    v_pk_add_f32 v[66:67], v[66:67], v[200:201]
    v_pk_fma_f32 v[70:71], v[200:201], v[200:201], v[70:71]
    s_waitcnt vmcnt(18)
    v_lshlrev_b32 v82, 16, v228
    v_and_b32 v90, s88, v228
    v_lshlrev_b32 v98, 16, v229
    v_and_b32 v106, s88, v229
    v_lshlrev_b32 v178, 16, v244
    v_and_b32 v186, s88, v244
    v_lshlrev_b32 v194, 16, v245
    v_and_b32 v202, s88, v245
    v_lshlrev_b32 v83, 16, v230
    v_and_b32 v91, s88, v230
    v_lshlrev_b32 v99, 16, v231
    v_and_b32 v107, s88, v231
    v_lshlrev_b32 v179, 16, v246
    v_and_b32 v187, s88, v246
    v_lshlrev_b32 v195, 16, v247
    v_and_b32_e64 v203, s88, v247
    v_pk_add_f32 v[64:65], v[64:65], v[82:83]
    v_pk_fma_f32 v[68:69], v[82:83], v[82:83], v[68:69]
    v_pk_add_f32 v[66:67], v[66:67], v[90:91]
    v_pk_fma_f32 v[70:71], v[90:91], v[90:91], v[70:71]
    v_pk_add_f32 v[64:65], v[64:65], v[98:99]
    v_pk_fma_f32 v[68:69], v[98:99], v[98:99], v[68:69]
    v_pk_add_f32 v[66:67], v[66:67], v[106:107]
    v_pk_fma_f32 v[70:71], v[106:107], v[106:107], v[70:71]
    v_pk_add_f32 v[64:65], v[64:65], v[178:179]
    v_pk_fma_f32 v[68:69], v[178:179], v[178:179], v[68:69]
    v_pk_add_f32 v[66:67], v[66:67], v[186:187]
    v_pk_fma_f32 v[70:71], v[186:187], v[186:187], v[70:71]
    v_pk_add_f32 v[64:65], v[64:65], v[194:195]
    v_pk_fma_f32 v[68:69], v[194:195], v[194:195], v[68:69]
    v_pk_add_f32 v[66:67], v[66:67], v[202:203]
    v_pk_fma_f32 v[70:71], v[202:203], v[202:203], v[70:71]
    s_waitcnt vmcnt(14)
    v_lshlrev_b32 v84, 16, v232
    v_and_b32 v92, s88, v232
    v_lshlrev_b32 v100, 16, v233
    v_and_b32 v108, s88, v233
    v_lshlrev_b32 v180, 16, v248
    v_and_b32 v188, s88, v248
    v_lshlrev_b32 v196, 16, v249
    v_and_b32 v204, s88, v249
    v_lshlrev_b32 v85, 16, v234
    v_and_b32 v93, s88, v234
    v_lshlrev_b32 v101, 16, v235
    v_and_b32 v109, s88, v235
    v_lshlrev_b32 v181, 16, v250
    v_and_b32 v189, s88, v250
    v_lshlrev_b32 v197, 16, v251
    v_and_b32_e64 v205, s88, v251
    v_pk_add_f32 v[64:65], v[64:65], v[84:85]
    v_pk_fma_f32 v[68:69], v[84:85], v[84:85], v[68:69]
    v_pk_add_f32 v[66:67], v[66:67], v[92:93]
    v_pk_fma_f32 v[70:71], v[92:93], v[92:93], v[70:71]
    v_pk_add_f32 v[64:65], v[64:65], v[100:101]
    v_pk_fma_f32 v[68:69], v[100:101], v[100:101], v[68:69]
    v_pk_add_f32 v[66:67], v[66:67], v[108:109]
    v_pk_fma_f32 v[70:71], v[108:109], v[108:109], v[70:71]
    v_pk_add_f32 v[64:65], v[64:65], v[180:181]
    v_pk_fma_f32 v[68:69], v[180:181], v[180:181], v[68:69]
    v_pk_add_f32 v[66:67], v[66:67], v[188:189]
    v_pk_fma_f32 v[70:71], v[188:189], v[188:189], v[70:71]
    v_pk_add_f32 v[64:65], v[64:65], v[196:197]
    v_pk_fma_f32 v[68:69], v[196:197], v[196:197], v[68:69]
    v_pk_add_f32 v[66:67], v[66:67], v[204:205]
    v_pk_fma_f32 v[70:71], v[204:205], v[204:205], v[70:71]
    s_waitcnt vmcnt(9)
    v_lshlrev_b32 v86, 16, v236
    v_and_b32 v94, s88, v236
    v_lshlrev_b32 v102, 16, v237
    v_and_b32 v110, s88, v237
    v_lshlrev_b32 v182, 16, v252
    v_and_b32 v190, s88, v252
    v_lshlrev_b32 v198, 16, v253
    v_and_b32 v206, s88, v253
    v_lshlrev_b32 v87, 16, v238
    v_and_b32 v95, s88, v238
    v_lshlrev_b32 v103, 16, v239
    v_and_b32 v111, s88, v239
    v_lshlrev_b32 v183, 16, v254
    v_and_b32 v191, s88, v254
    v_lshlrev_b32 v199, 16, v255
    v_and_b32_e64 v207, s88, v255
    v_pk_add_f32 v[64:65], v[64:65], v[86:87]
    v_pk_fma_f32 v[68:69], v[86:87], v[86:87], v[68:69]
    v_pk_add_f32 v[66:67], v[66:67], v[94:95]
    v_pk_fma_f32 v[70:71], v[94:95], v[94:95], v[70:71]
    v_pk_add_f32 v[64:65], v[64:65], v[102:103]
    v_pk_fma_f32 v[68:69], v[102:103], v[102:103], v[68:69]
    v_pk_add_f32 v[66:67], v[66:67], v[110:111]
    v_pk_fma_f32 v[70:71], v[110:111], v[110:111], v[70:71]
    v_pk_add_f32 v[64:65], v[64:65], v[182:183]
    v_pk_fma_f32 v[68:69], v[182:183], v[182:183], v[68:69]
    v_pk_add_f32 v[66:67], v[66:67], v[190:191]
    v_pk_fma_f32 v[70:71], v[190:191], v[190:191], v[70:71]
    v_pk_add_f32 v[64:65], v[64:65], v[198:199]
    v_pk_fma_f32 v[68:69], v[198:199], v[198:199], v[68:69]
    v_pk_add_f32 v[66:67], v[66:67], v[206:207]
    v_pk_fma_f32 v[70:71], v[206:207], v[206:207], v[70:71]
    s_lshl3_add_u32 s37, s3, 160016
    v_pk_add_f32 v[64:65], v[64:65], v[66:67]
    v_pk_add_f32 v[68:69], v[68:69], v[70:71]
    v_add_f32 v64, v64, v65
    v_add_f32 v65, v68, v69
    v_mov_b32_e64 v149, s37
    v_add_f32_dpp v64, v64, v64 row_shr:1 row_mask:0xf bank_mask:0xf bound_ctrl:1
    v_add_f32_dpp v65, v65, v65 row_shr:1 row_mask:0xf bank_mask:0xf bound_ctrl:1
    v_mov_b32 v74, 160016
    v_add_f32_dpp v64, v64, v64 row_shr:2 row_mask:0xf bank_mask:0xf bound_ctrl:1
    v_add_f32_dpp v65, v65, v65 row_shr:2 row_mask:0xf bank_mask:0xf bound_ctrl:1
    v_add_u32 v40, 49152, v9
    v_add_f32_dpp v64, v64, v64 row_shr:4 row_mask:0xf bank_mask:0xf bound_ctrl:1
    v_add_f32_dpp v65, v65, v65 row_shr:4 row_mask:0xf bank_mask:0xf bound_ctrl:1
    v_lshrrev_b32_e64 v41, 1, v12
    v_add_f32_dpp v64, v64, v64 row_shr:8 row_mask:0xf bank_mask:0xf bound_ctrl:1
    v_add_f32_dpp v65, v65, v65 row_shr:8 row_mask:0xf bank_mask:0xf bound_ctrl:1
    v_add_u32 v41, 49152, v41
    v_add_f32_dpp v64, v64, v64 row_bcast:15 row_mask:0xa bank_mask:0xf
    v_add_f32_dpp v65, v65, v65 row_bcast:15 row_mask:0xa bank_mask:0xf
    v_mov_b32 v24, 0x44354000
    v_add_f32_dpp v64, v64, v64 row_bcast:31 row_mask:0xc bank_mask:0xf
    v_add_f32_dpp v65, v65, v65 row_bcast:31 row_mask:0xc bank_mask:0xf
    s_lshl_b64 exec, 1, 63
    ds_write_b64 v149, v[64:65]
    s_mov_b64 exec, -1
    s_waitcnt lgkmcnt(0)
    s_barrier
    ds_read_b128 v[16:19], v40
    ds_read_b128 v[20:23], v40 offset:1024
    ds_read_b128 v[28:31], v41
    ds_read_b128 v[32:35], v41 offset:1024
    s_add_u32 m0, s96, 0
    s_add_u32 s97, s70, 0
    buffer_load_dwordx4 v9, s[20:23], s97 offen offset:0 lds
    s_waitcnt lgkmcnt(0)
    s_nop 0
    v_and_b32 v16, 0x7fff7fff, v16
    v_and_b32 v17, 0x7fff7fff, v17
    v_and_b32 v18, 0x7fff7fff, v18
    v_and_b32 v19, 0x7fff7fff, v19
    buffer_load_dwordx4 v9, s[20:23], s97 offen offset:1024 lds
    v_pk_max_u16 v16, v16, v17
    v_pk_max_u16 v18, v18, v19
    v_pk_max_u16 v16, v16, v18
    v_lshlrev_b32 v17, 16, v16
    v_and_b32 v18, s88, v16
    v_max_u32_e64 v16, v17, v18
    v_and_b32 v20, 0x7fff7fff, v20
    v_and_b32 v21, 0x7fff7fff, v21
    s_cmp_lg_u32 s3, 0
    s_cbranch_scc1 L_else3
    global_load_dwordx4 v[76:79], v75, s[92:93] sc1
L_else3:
    buffer_load_dwordx4 v9, s[20:23], s97 offen offset:2048 lds
    v_and_b32 v22, 0x7fff7fff, v22
    v_and_b32 v23, 0x7fff7fff, v23
    v_pk_max_u16 v20, v20, v21
    v_pk_max_u16 v22, v22, v23
    v_pk_max_u16 v20, v20, v22
    v_lshlrev_b32 v21, 16, v20
    v_and_b32 v22, s88, v20
    v_max_u32_e64 v20, v21, v22
    buffer_load_dwordx4 v9, s[20:23], s97 offen offset:3072 lds
    v_fma_f32 v24, v16, v24, v20
    v_lshlrev_b32 v208, 16, v28
    v_and_b32 v209, s88, v28
    v_lshlrev_b32_e64 v216, 16, v32
    v_max_u32_dpp v24, v24, v24 row_shr:1 row_mask:0xf bank_mask:0xf bound_ctrl:1
    v_and_b32 v217, s88, v32
    v_lshlrev_b32 v210, 16, v29
    v_and_b32_e64 v211, s88, v29
    s_add_u32 m0, s96, 4096
    s_add_u32 s97, s70, 4096
    buffer_load_dwordx4 v9, s[20:23], s97 offen offset:0 lds
    v_max_u32_dpp v24, v24, v24 row_shr:2 row_mask:0xf bank_mask:0xf bound_ctrl:1
    v_lshlrev_b32 v218, 16, v33
    v_and_b32 v219, s88, v33
    v_max_u32_dpp v24, v24, v24 row_shr:4 row_mask:0xf bank_mask:0xf bound_ctrl:1
    v_lshlrev_b32 v212, 16, v30
    v_and_b32 v213, s88, v30
    v_lshlrev_b32_e64 v220, 16, v34
    v_max_u32_dpp v24, v24, v24 row_shr:8 row_mask:0xf bank_mask:0xf bound_ctrl:1
    buffer_load_dwordx4 v9, s[20:23], s97 offen offset:1024 lds
    v_and_b32 v221, s88, v34
    v_lshlrev_b32 v214, 16, v31
    v_and_b32_e64 v215, s88, v31
    v_max_u32_dpp v24, v24, v24 row_bcast:15 row_mask:0xa bank_mask:0xf
    v_lshlrev_b32 v222, 16, v35
    v_and_b32 v223, s88, v35
    v_max_u32_dpp v24, v24, v24 row_bcast:31 row_mask:0xc bank_mask:0xf
    s_mov_b32 s38, 0xbfb8aa3b
    buffer_load_dwordx4 v9, s[20:23], s97 offen offset:2048 lds
    v_frexp_exp_i32_f32_e64 v24, v24
    v_pk_mul_f32 v[208:209], v[208:209], s[38:39] op_sel_hi:[1,0]
    v_readlane_b32 s52, v24, 63
    v_pk_mul_f32 v[210:211], v[210:211], s[38:39] op_sel_hi:[1,0]
    v_pk_mul_f32 v[212:213], v[212:213], s[38:39] op_sel_hi:[1,0]
    v_pk_mul_f32 v[214:215], v[214:215], s[38:39] op_sel_hi:[1,0]
    v_pk_mul_f32 v[216:217], v[216:217], s[38:39] op_sel_hi:[1,0]
    v_pk_mul_f32 v[218:219], v[218:219], s[38:39] op_sel_hi:[1,0]
    buffer_load_dwordx4 v9, s[20:23], s97 offen offset:3072 lds
    v_pk_mul_f32 v[220:221], v[220:221], s[38:39] op_sel_hi:[1,0]
    v_pk_mul_f32 v[222:223], v[222:223], s[38:39] op_sel_hi:[1,0]
    s_max_i32 s52, s52, -100
    s_min_i32 s52, s52, 120
    s_add_i32 s52, s52, 114
    s_lshl_b32 s52, s52, 23
    s_or_b32 s53, s52, 0x8038aa3b
    s_add_u32 m0, s96, 8192
    s_add_u32 s97, s70, 8192
    buffer_load_dwordx4 v9, s[20:23], s97 offen offset:0 lds
    s_getreg_b32 s47, hwreg(HW_REG_XCC_ID)
    s_lshl_b32 s37, s32, 5
    s_add_u32 s37, s37, s33
    s_lshl_b32 s37, s37, 6
    s_add_u32 s86, s37, 196608
    v_and_b32 v151, 48, v9
    v_mul_u32_u24 v151, 580, v151
    v_bfe_u32 v150, v9, 6, 2
    v_mul_u32_u24 v150, 144, v150
    s_mul_i32 s37, s3, 576
    s_add_u32 s37, s37, 122880
    v_add3_u32 v151, v151, v150, s37
    v_and_b32 v150, 0x300, v9
    v_mad_u32_u24 v151, v150, 9, v151
    s_cmp_eq_u32 s3, 0
    s_cbranch_scc1 L_else5
    s_cmp_lg_u32 s3, 3
    s_cbranch_scc1 L_else4
    v_lshlrev_b32 v140, 16, v140
    v_lshlrev_b32 v141, 16, v141
    v_lshlrev_b32_e64 v142, 16, v142
    v_mul_f32 v56, 0xbfb8aa3b, v140
    v_mul_f32 v58, 0xbfb8aa3b, v141
    v_mul_f32 v60, 0xbfb8aa3b, v142
    v_exp_f32 v56, v56
    v_exp_f32 v58, v58
    v_exp_f32 v60, v60
    v_add_f32 v56, 1.0, v56
    v_add_f32 v58, 1.0, v58
    v_add_f32 v60, 1.0, v60
    v_rcp_f32 v56, v56
    v_rcp_f32 v58, v58
    v_rcp_f32 v60, v60
    v_mul_f32 v56, v140, v56
    v_mul_f32 v58, v141, v58
    v_mul_f32 v60, v142, v60
    v_lshlrev_b32 v48, 16, v128
    v_and_b32 v49, s88, v128
    v_lshlrev_b32 v50, 16, v129
    v_and_b32 v51, s88, v129
    v_lshlrev_b32 v52, 16, v130
    v_and_b32 v53, s88, v130
    v_lshlrev_b32 v54, 16, v131
    v_and_b32 v55, s88, v131
    v_pk_mul_f32 v[40:41], v[48:49], v[56:57] op_sel_hi:[1,0]
    v_pk_mul_f32 v[42:43], v[50:51], v[56:57] op_sel_hi:[1,0]
    v_pk_mul_f32 v[44:45], v[52:53], v[56:57] op_sel_hi:[1,0]
    v_pk_mul_f32 v[46:47], v[54:55], v[56:57] op_sel_hi:[1,0]
    v_lshlrev_b32 v48, 16, v132
    v_and_b32 v49, s88, v132
    v_lshlrev_b32 v50, 16, v133
    v_and_b32 v51, s88, v133
    v_lshlrev_b32 v52, 16, v134
    v_and_b32 v53, s88, v134
    v_lshlrev_b32 v54, 16, v135
    v_and_b32 v55, s88, v135
    v_pk_fma_f32 v[40:41], v[48:49], v[58:59], v[40:41] op_sel_hi:[1,0,1]
    v_pk_fma_f32 v[42:43], v[50:51], v[58:59], v[42:43] op_sel_hi:[1,0,1]
    v_pk_fma_f32 v[44:45], v[52:53], v[58:59], v[44:45] op_sel_hi:[1,0,1]
    v_pk_fma_f32 v[46:47], v[54:55], v[58:59], v[46:47] op_sel_hi:[1,0,1]
    v_lshlrev_b32 v48, 16, v136
    v_and_b32 v49, s88, v136
    v_lshlrev_b32 v50, 16, v137
    v_and_b32 v51, s88, v137
    v_lshlrev_b32 v52, 16, v138
    v_and_b32 v53, s88, v138
    v_lshlrev_b32 v54, 16, v139
    v_and_b32 v55, s88, v139
    v_pk_fma_f32 v[40:41], v[48:49], v[60:61], v[40:41] op_sel_hi:[1,0,1]
    v_pk_fma_f32 v[42:43], v[50:51], v[60:61], v[42:43] op_sel_hi:[1,0,1]
    v_pk_fma_f32 v[44:45], v[52:53], v[60:61], v[44:45] op_sel_hi:[1,0,1]
    v_pk_fma_f32 v[46:47], v[54:55], v[60:61], v[46:47] op_sel_hi:[1,0,1]
    s_nop 0
    v_permlane32_swap_b32 v40, v44
    v_permlane32_swap_b32 v41, v45
    v_permlane32_swap_b32 v42, v46
    v_permlane32_swap_b32 v43, v47
    v_pk_add_f32 v[40:41], v[40:41], v[44:45]
    v_pk_add_f32 v[42:43], v[42:43], v[46:47]
    s_nop 1
    v_permlane16_swap_b32 v40, v42
    v_permlane16_swap_b32 v41, v43
    v_pk_add_f32 v[40:41], v[40:41], v[42:43]
    v_and_b32 v48, 0x70, v9
    v_lshrrev_b32 v49, 8, v9
    v_lshlrev_b32 v49, 3, v49
    v_lshl_add_u32 v48, v48, 1, v49
    v_add_f32_dpp v40, v40, v40 row_ror:8 row_mask:0xf bank_mask:0xf
    v_add_f32_dpp v41, v41, v41 row_ror:8 row_mask:0xf bank_mask:0xf
    s_lshl3_add_u32 s37, s34, s35
    s_lshl4_add_u32 s37, s37, s36
    s_lshl_b32 s37, s37, 8
    s_add_u32 s37, s37, 131072
    s_waitcnt vmcnt(9)
    buffer_store_dwordx2 v[40:41], v48, s[16:19], s37 offen sc1
    s_branch L_fi4
L_else4:
    v_mov_b32 v164, 0
    v_mov_b32 v165, 0
    v_mov_b32 v166, 0
    v_mov_b32 v167, 0
    s_lshl_b32 s37, s2, 7
    s_add_u32 s37, s37, 32784
    s_cmp_eq_u32 s3, 1
    s_cselect_b32 s37, s37, s86
    s_waitcnt vmcnt(9)
    s_cselect_b64 exec, 1, 7
    buffer_store_dwordx4 v[164:167], v9, s[16:19], s37 offen sc1
    s_mov_b64 exec, -1
L_fi4:
    s_branch L_fi5
L_else5:
    ds_read_b128 v[168:171], v74
    ds_read_b128 v[172:175], v74 offset:16
    s_waitcnt lgkmcnt(0)
    v_pk_add_f32 v[168:169], v[168:169], v[170:171]
    v_pk_add_f32 v[172:173], v[172:173], v[174:175]
    v_mov_b32 v170, 0
    v_mov_b32_e64 v171, s47
    v_pk_add_f32 v[168:169], v[168:169], v[172:173]
    v_and_b32 v169, 0x7fffffff, v169
L_w2:
    s_mov_b32 s37, 262144
    s_waitcnt vmcnt(7)
L_mask:
    v_readfirstlane_b32 s39, v78
    v_readfirstlane_b32 s72, v76
    s_cmp_eq_u32 s39, 1
    s_cbranch_scc1 L_mask_out
    global_load_dwordx4 v[76:79], v75, s[92:93] sc1
    s_waitcnt vmcnt(0)
    s_sub_u32 s37, s37, 1
    s_cbranch_scc0 L_mask
L_mask_out:
    s_lshr_b32 s39, s72, s33
    s_lshl_b32 s39, s39, 31
    v_or_b32 v169, s39, v169
    s_mov_b64 exec, 1
    buffer_store_dwordx4 v[168:171], v9, s[16:19], s71 offen sc1
    s_mov_b64 exec, -1
L_fi5:
    s_barrier
    ds_read_b128 v[112:115], v151 offset:0
    ds_read_b128 v[116:119], v151 offset:16
    ds_read_b128 v[120:123], v151 offset:32
    ds_read_b128 v[124:127], v151 offset:48
    ds_read_b128 v[128:131], v151 offset:64
    ds_read_b128 v[132:135], v151 offset:80
    ds_read_b128 v[136:139], v151 offset:96
    ds_read_b128 v[140:143], v151 offset:112
    ds_read_b128 v[144:147], v151 offset:128
    v_mov_b32 v77, 160016
    v_mov_b32 v150, 0
    s_cmp_eq_u32 s31, 0
    s_cselect_b32 s38, 1.0, -1.0
    s_lshl2_add_u32 s37, s3, 160000
    v_mov_b32 v151, s37
    s_waitcnt lgkmcnt(7)
    v_lshlrev_b32 v16, 16, v112
    v_and_b32_e64 v24, s88, v112
    v_max3_f32 v150, abs(v16), abs(v24), v150
    v_lshlrev_b32 v32, 16, v113
    v_and_b32 v40, s88, v113
    v_max3_f32 v150, abs(v32), abs(v40), v150
    v_lshlrev_b32 v48, 16, v114
    v_and_b32 v56, s88, v114
    v_max3_f32 v150, abs(v48), abs(v56), v150
    v_lshlrev_b32 v152, 16, v115
    v_and_b32 v160, s88, v115
    v_max3_f32 v150, abs(v152), abs(v160), v150
    v_lshlrev_b32 v168, 16, v116
    v_and_b32 v17, s88, v116
    v_max3_f32 v150, abs(v168), abs(v17), v150
    v_lshlrev_b32 v25, 16, v117
    v_and_b32 v33, s88, v117
    v_max3_f32 v150, abs(v25), abs(v33), v150
    v_lshlrev_b32 v41, 16, v118
    v_and_b32 v49, s88, v118
    v_max3_f32 v150, abs(v41), abs(v49), v150
    v_lshlrev_b32 v57, 16, v119
    v_and_b32 v153, s88, v119
    v_max3_f32 v150, abs(v57), abs(v153), v150
    s_waitcnt lgkmcnt(5)
    v_lshlrev_b32 v161, 16, v120
    v_and_b32_e64 v169, s88, v120
    v_max3_f32 v150, abs(v161), abs(v169), v150
    v_lshlrev_b32 v18, 16, v121
    v_and_b32 v26, s88, v121
    v_max3_f32 v150, abs(v18), abs(v26), v150
    v_lshlrev_b32 v34, 16, v122
    v_and_b32 v42, s88, v122
    v_max3_f32 v150, abs(v34), abs(v42), v150
    v_lshlrev_b32 v50, 16, v123
    v_and_b32 v58, s88, v123
    v_max3_f32 v150, abs(v50), abs(v58), v150
    v_lshlrev_b32 v154, 16, v124
    v_and_b32 v162, s88, v124
    v_max3_f32 v150, abs(v154), abs(v162), v150
    v_lshlrev_b32 v170, 16, v125
    v_and_b32 v19, s88, v125
    v_max3_f32 v150, abs(v170), abs(v19), v150
    v_lshlrev_b32 v27, 16, v126
    v_and_b32 v35, s88, v126
    v_max3_f32 v150, abs(v27), abs(v35), v150
    v_lshlrev_b32 v43, 16, v127
    v_and_b32 v51, s88, v127
    v_max3_f32 v150, abs(v43), abs(v51), v150
    s_waitcnt lgkmcnt(3)
    v_lshlrev_b32 v59, 16, v128
    v_and_b32_e64 v155, s88, v128
    v_max3_f32 v150, abs(v59), abs(v155), v150
    v_lshlrev_b32 v163, 16, v129
    v_and_b32 v171, s88, v129
    v_max3_f32 v150, abs(v163), abs(v171), v150
    v_lshlrev_b32 v20, 16, v130
    v_and_b32 v28, s88, v130
    v_max3_f32 v150, abs(v20), abs(v28), v150
    v_lshlrev_b32 v36, 16, v131
    v_and_b32 v44, s88, v131
    v_max3_f32 v150, abs(v36), abs(v44), v150
    v_lshlrev_b32 v52, 16, v132
    v_and_b32 v60, s88, v132
    v_max3_f32 v150, abs(v52), abs(v60), v150
    v_lshlrev_b32 v156, 16, v133
    v_and_b32 v164, s88, v133
    v_max3_f32 v150, abs(v156), abs(v164), v150
    v_lshlrev_b32 v172, 16, v134
    v_and_b32 v21, s88, v134
    v_max3_f32 v150, abs(v172), abs(v21), v150
    v_lshlrev_b32 v29, 16, v135
    v_and_b32 v37, s88, v135
    v_max3_f32 v150, abs(v29), abs(v37), v150
    s_waitcnt lgkmcnt(1)
    v_lshlrev_b32 v45, 16, v136
    v_and_b32_e64 v53, s88, v136
    v_max3_f32 v150, abs(v45), abs(v53), v150
    v_lshlrev_b32 v61, 16, v137
    v_and_b32 v157, s88, v137
    v_max3_f32 v150, abs(v61), abs(v157), v150
    v_lshlrev_b32 v165, 16, v138
    v_and_b32 v173, s88, v138
    v_max3_f32 v150, abs(v165), abs(v173), v150
    v_lshlrev_b32 v22, 16, v139
    v_and_b32 v30, s88, v139
    v_max3_f32 v150, abs(v22), abs(v30), v150
    v_lshlrev_b32 v38, 16, v140
    v_and_b32 v46, s88, v140
    v_max3_f32 v150, abs(v38), abs(v46), v150
    v_lshlrev_b32 v54, 16, v141
    v_and_b32 v62, s88, v141
    v_max3_f32 v150, abs(v54), abs(v62), v150
    v_lshlrev_b32 v158, 16, v142
    v_and_b32 v166, s88, v142
    v_max3_f32 v150, abs(v158), abs(v166), v150
    v_lshlrev_b32 v174, 16, v143
    v_and_b32 v23, s88, v143
    v_max3_f32 v150, abs(v174), abs(v23), v150
    s_waitcnt lgkmcnt(0)
    v_lshlrev_b32 v31, 16, v144
    v_and_b32_e64 v39, s88, v144
    v_max3_f32 v150, abs(v31), abs(v39), v150
    v_lshlrev_b32 v47, 16, v145
    v_and_b32 v55, s88, v145
    v_max3_f32 v150, abs(v47), abs(v55), v150
    v_lshlrev_b32 v63, 16, v146
    v_and_b32 v159, s88, v146
    v_max3_f32 v150, abs(v63), abs(v159), v150
    v_lshlrev_b32 v167, 16, v147
    v_and_b32 v175, s88, v147
    v_max3_f32 v150, abs(v167), abs(v175), v150
    v_pk_fma_f32 v[40:41], v[40:41], s[38:39], v[16:17] op_sel_hi:[1,0,1]
    v_pk_fma_f32 v[42:43], v[42:43], s[38:39], v[18:19] op_sel_hi:[1,0,1]
    v_pk_fma_f32 v[44:45], v[44:45], s[38:39], v[20:21] op_sel_hi:[1,0,1]
    v_max_u32_dpp v150, v150, v150 row_shr:1 row_mask:0xf bank_mask:0xf bound_ctrl:1
    v_pk_fma_f32 v[46:47], v[46:47], s[38:39], v[22:23] op_sel_hi:[1,0,1]
    v_pk_fma_f32 v[48:49], v[48:49], s[38:39], v[24:25] op_sel_hi:[1,0,1]
    v_pk_fma_f32 v[50:51], v[50:51], s[38:39], v[26:27] op_sel_hi:[1,0,1]
    v_max_u32_dpp v150, v150, v150 row_shr:2 row_mask:0xf bank_mask:0xf bound_ctrl:1
    v_pk_fma_f32 v[52:53], v[52:53], s[38:39], v[28:29] op_sel_hi:[1,0,1]
    v_pk_fma_f32 v[54:55], v[54:55], s[38:39], v[30:31] op_sel_hi:[1,0,1]
    v_pk_fma_f32 v[56:57], v[56:57], s[38:39], v[32:33] op_sel_hi:[1,0,1]
    v_max_u32_dpp v150, v150, v150 row_shr:4 row_mask:0xf bank_mask:0xf bound_ctrl:1
    v_pk_fma_f32 v[58:59], v[58:59], s[38:39], v[34:35] op_sel_hi:[1,0,1]
    v_pk_fma_f32 v[60:61], v[60:61], s[38:39], v[36:37] op_sel_hi:[1,0,1]
    v_pk_fma_f32 v[62:63], v[62:63], s[38:39], v[38:39] op_sel_hi:[1,0,1]
    v_max_u32_dpp v150, v150, v150 row_shr:8 row_mask:0xf bank_mask:0xf bound_ctrl:1
    v_pk_add_f32 v[40:41], v[40:41], v[152:153]
    v_pk_add_f32 v[42:43], v[42:43], v[154:155]
    v_pk_add_f32 v[44:45], v[44:45], v[156:157]
    v_max_u32_dpp v150, v150, v150 row_bcast:15 row_mask:0xa bank_mask:0xf
    v_pk_add_f32 v[46:47], v[46:47], v[158:159]
    v_pk_add_f32 v[48:49], v[48:49], v[160:161]
    v_pk_add_f32 v[50:51], v[50:51], v[162:163]
    v_max_u32_dpp v150, v150, v150 row_bcast:31 row_mask:0xc bank_mask:0xf
    s_lshl_b64 exec, 1, 63
    ds_write_b32 v151, v150
    s_mov_b64 exec, -1
    v_mov_b32 v151, 160000
    v_pk_add_f32 v[52:53], v[52:53], v[164:165]
    v_pk_add_f32 v[54:55], v[54:55], v[166:167]
    v_pk_add_f32 v[56:57], v[56:57], v[168:169]
    v_pk_add_f32 v[58:59], v[58:59], v[170:171]
    v_pk_add_f32 v[60:61], v[60:61], v[172:173]
    v_pk_add_f32 v[62:63], v[62:63], v[174:175]
    s_cmp_lg_u32 s31, 0
    s_cbranch_scc1 L_else6
    v_pk_add_f32 v[64:65], v[24:25], v[32:33]
    v_pk_add_f32 v[66:67], v[26:27], v[34:35]
    v_pk_add_f32 v[68:69], v[28:29], v[36:37]
    v_pk_add_f32 v[70:71], v[30:31], v[38:39]
    v_pk_add_f32 v[24:25], v[16:17], v[64:65]
    v_pk_add_f32 v[26:27], v[18:19], v[66:67]
    v_pk_add_f32 v[28:29], v[20:21], v[68:69]
    v_pk_add_f32 v[30:31], v[22:23], v[70:71]
    v_pk_add_f32 v[16:17], v[16:17], v[64:65] neg_lo:[0,1] neg_hi:[0,1]
    v_pk_add_f32 v[18:19], v[18:19], v[66:67] neg_lo:[0,1] neg_hi:[0,1]
    v_pk_add_f32 v[20:21], v[20:21], v[68:69] neg_lo:[0,1] neg_hi:[0,1]
    v_pk_add_f32 v[22:23], v[22:23], v[70:71] neg_lo:[0,1] neg_hi:[0,1]
    s_branch L_fi6
    s_nop 0
L_else6:
    v_pk_add_f32 v[64:65], v[160:161], v[168:169]
    v_pk_add_f32 v[66:67], v[162:163], v[170:171]
    v_pk_add_f32 v[68:69], v[164:165], v[172:173]
    v_pk_add_f32 v[70:71], v[166:167], v[174:175]
    v_pk_mov_b32 v[32:33], v[168:169], v[168:169] op_sel:[0,1]
    v_pk_mov_b32 v[34:35], v[170:171], v[170:171] op_sel:[0,1]
    v_pk_mov_b32 v[36:37], v[172:173], v[172:173] op_sel:[0,1]
    v_pk_mov_b32 v[38:39], v[174:175], v[174:175] op_sel:[0,1]
    v_pk_add_f32 v[24:25], v[152:153], v[64:65]
    v_pk_add_f32 v[26:27], v[154:155], v[66:67]
    v_pk_add_f32 v[28:29], v[156:157], v[68:69]
    v_pk_add_f32 v[30:31], v[158:159], v[70:71]
    v_pk_add_f32 v[16:17], v[152:153], v[64:65] neg_lo:[0,1] neg_hi:[0,1]
    v_pk_add_f32 v[18:19], v[154:155], v[66:67] neg_lo:[0,1] neg_hi:[0,1]
    v_pk_add_f32 v[20:21], v[156:157], v[68:69] neg_lo:[0,1] neg_hi:[0,1]
    v_pk_add_f32 v[22:23], v[158:159], v[70:71] neg_lo:[0,1] neg_hi:[0,1]
L_fi6:
    s_cmp_eq_u32 s3, 0
    s_cselect_b64 s[22:23], -1, 0
    s_lshr_b64 s[20:21], s[22:23], 32
    s_mov_b32 s96, s86
    s_mov_b32 exec_hi, 0
    buffer_load_dwordx4 v[72:75], v13, s[16:19], s45 offen sc1
    s_mov_b64 exec, -1
    s_waitcnt lgkmcnt(0)
    s_barrier
    ds_read_b128 v[112:115], v151
    v_pk_add_f32 v[64:65], v[48:49], v[56:57]
    v_pk_add_f32 v[66:67], v[50:51], v[58:59]
    v_pk_add_f32 v[68:69], v[52:53], v[60:61]
    v_pk_add_f32 v[70:71], v[54:55], v[62:63]
    v_pk_add_f32 v[48:49], v[40:41], v[64:65]
    v_pk_add_f32 v[50:51], v[42:43], v[66:67]
    v_pk_add_f32 v[52:53], v[44:45], v[68:69]
    v_pk_add_f32 v[54:55], v[46:47], v[70:71]
    v_pk_add_f32 v[40:41], v[40:41], v[64:65] neg_lo:[0,1] neg_hi:[0,1]
    v_pk_add_f32 v[42:43], v[42:43], v[66:67] neg_lo:[0,1] neg_hi:[0,1]
    v_pk_add_f32 v[44:45], v[44:45], v[68:69] neg_lo:[0,1] neg_hi:[0,1]
    v_pk_add_f32 v[46:47], v[46:47], v[70:71] neg_lo:[0,1] neg_hi:[0,1]
    s_waitcnt lgkmcnt(0)
    v_max3_f32 v150, v112, v113, v114
    v_max_f32 v150, v150, v115
    v_frexp_exp_i32_f32 v150, v150
    s_nop 0
    v_readfirstlane_b32 s39, v150
    s_nop 0
    s_max_i32 s39, s39, -100
    s_min_i32 s39, s39, 128
    s_sub_i32 s80, 140, s39
    s_lshl_b32 s80, s80, 23
    s_sub_u32 s81, s80, 0x800000
    s_sub_u32 s82, s80, 0x1000000
    s_add_i32 s39, s39, 114
    s_lshl_b32 s39, s39, 23
    v_pk_mul_f32 v[32:33], v[32:33], s[80:81] op_sel_hi:[1,0]
    v_pk_mul_f32 v[34:35], v[34:35], s[80:81] op_sel_hi:[1,0]
    v_pk_mul_f32 v[36:37], v[36:37], s[80:81] op_sel_hi:[1,0]
    v_pk_mul_f32 v[38:39], v[38:39], s[80:81] op_sel_hi:[1,0]
    v_pk_mul_f32 v[24:25], v[24:25], s[80:81] op_sel:[0,1]
    v_pk_mul_f32 v[26:27], v[26:27], s[80:81] op_sel:[0,1]
    v_pk_mul_f32 v[28:29], v[28:29], s[80:81] op_sel:[0,1]
    v_pk_mul_f32 v[30:31], v[30:31], s[80:81] op_sel:[0,1]
    v_pk_mul_f32 v[16:17], v[16:17], s[80:81] op_sel:[0,1]
    v_pk_mul_f32 v[18:19], v[18:19], s[80:81] op_sel:[0,1]
    v_pk_mul_f32 v[20:21], v[20:21], s[80:81] op_sel:[0,1]
    v_pk_mul_f32 v[22:23], v[22:23], s[80:81] op_sel:[0,1]
    v_pk_mul_f32 v[56:57], v[56:57], s[80:81] op_sel:[0,1]
    v_pk_mul_f32 v[58:59], v[58:59], s[80:81] op_sel:[0,1]
    v_pk_mul_f32 v[60:61], v[60:61], s[80:81] op_sel:[0,1]
    v_pk_mul_f32 v[62:63], v[62:63], s[80:81] op_sel:[0,1]
    v_pk_mul_f32 v[48:49], v[48:49], s[82:83] op_sel_hi:[1,0]
    v_pk_mul_f32 v[50:51], v[50:51], s[82:83] op_sel_hi:[1,0]
    v_pk_mul_f32 v[52:53], v[52:53], s[82:83] op_sel_hi:[1,0]
    v_pk_mul_f32 v[54:55], v[54:55], s[82:83] op_sel_hi:[1,0]
    v_pk_mul_f32 v[40:41], v[40:41], s[82:83] op_sel_hi:[1,0]
    v_pk_mul_f32 v[42:43], v[42:43], s[82:83] op_sel_hi:[1,0]
    v_pk_mul_f32 v[44:45], v[44:45], s[82:83] op_sel_hi:[1,0]
    v_pk_mul_f32 v[46:47], v[46:47], s[82:83] op_sel_hi:[1,0]
    v_cvt_pk_f16_f32 v32, v32, v33
    v_cvt_pk_f16_f32 v33, v34, v35
    v_cvt_pk_f16_f32 v34, v36, v37
    v_cvt_pk_f16_f32 v35, v38, v39
    v_cvt_pk_f16_f32 v24, v24, v25
    v_cvt_pk_f16_f32 v25, v26, v27
    v_cvt_pk_f16_f32 v26, v28, v29
    v_cvt_pk_f16_f32 v27, v30, v31
    v_cvt_pk_f16_f32 v16, v16, v17
    v_cvt_pk_f16_f32 v17, v18, v19
    v_cvt_pk_f16_f32 v18, v20, v21
    v_cvt_pk_f16_f32 v19, v22, v23
    v_cvt_pk_f16_f32 v56, v56, v57
    v_cvt_pk_f16_f32 v57, v58, v59
    v_cvt_pk_f16_f32 v58, v60, v61
    v_cvt_pk_f16_f32 v59, v62, v63
    v_cvt_pk_f16_f32 v48, v48, v49
    v_cvt_pk_f16_f32 v49, v50, v51
    v_cvt_pk_f16_f32 v50, v52, v53
    v_cvt_pk_f16_f32 v51, v54, v55
    v_cvt_pk_f16_f32 v40, v40, v41
    v_cvt_pk_f16_f32 v41, v42, v43
    v_cvt_pk_f16_f32 v42, v44, v45
    v_cvt_pk_f16_f32 v43, v46, v47
    s_waitcnt vmcnt(0)
    v_lshrrev_b32 v150, 2, v9
    v_mov_b32 v151, s39
    s_mov_b64 exec, 15
    buffer_store_dword v151, v150, s[16:19], s68 offen offset:0 sc1
    s_mov_b64 exec, -1
    v_cmp_gt_i32 vcc, 0, v73
    s_nop 0
    s_xor_b64 vcc, vcc, s[72:73]
    s_and_b64 vcc, vcc, s[20:21]
    s_cbranch_scc1 L_pstat0_slow
L_pstat0_out:
    v_and_b32 v73, 0x7fffffff, v73
    v_lshrrev_b32_e64 v120, 2, v11
    v_add_f32_dpp v72, v72, v72 row_shr:1 row_mask:0xf bank_mask:0xf bound_ctrl:1
    v_add_f32_dpp v73, v73, v73 row_shr:1 row_mask:0xf bank_mask:0xf bound_ctrl:1
    v_and_b32 v120, 0xe0, v120
    v_add_f32_dpp v72, v72, v72 row_shr:2 row_mask:0xf bank_mask:0xf bound_ctrl:1
    v_add_f32_dpp v73, v73, v73 row_shr:2 row_mask:0xf bank_mask:0xf bound_ctrl:1
    v_lshrrev_b32_e64 v121, 2, v14
    v_add_f32_dpp v72, v72, v72 row_shr:4 row_mask:0xf bank_mask:0xf bound_ctrl:1
    v_add_f32_dpp v73, v73, v73 row_shr:4 row_mask:0xf bank_mask:0xf bound_ctrl:1
    v_and_b32 v121, 0xe0, v121
    v_add_f32_dpp v72, v72, v72 row_shr:8 row_mask:0xf bank_mask:0xf bound_ctrl:1
    v_add_f32_dpp v73, v73, v73 row_shr:8 row_mask:0xf bank_mask:0xf bound_ctrl:1
    s_nop 0
    s_nop 0
    v_add_f32_dpp v72, v72, v72 row_bcast:15 row_mask:0xa bank_mask:0xf
    v_add_f32_dpp v73, v73, v73 row_bcast:15 row_mask:0xa bank_mask:0xf
    v_mul_f32 v72, 0x36000000, v72
    v_mul_f32 v73, 0x36000000, v73
    v_fma_f32 v73, -v72, v72, v73
    v_max_f32_e64 v73, 0, v73
    v_add_f32 v73, 0x3727c5ac, v73
    v_rsq_f32 v73, v73
    s_and_b32 s37, s32, 3
    s_lshl_b32 s37, s37, 4
    s_lshl_b64 s[20:21], 0xffff, s37
    s_lshl_b64 exec, 1, 31
    ds_write_b64 v149, v[72:73] offset:32
    s_mov_b64 exec, -1
    global_load_dwordx4 v[112:115], v120, s[92:93] sc1
    global_load_dwordx4 v[116:119], v121, s[92:93] sc1
    s_waitcnt lgkmcnt(0)
    s_barrier
    ds_read_b64 v[72:73], v77 offset:32
    s_mov_b64 exec, s[20:21]
    buffer_store_dwordx4 v[32:35], v148, s[48:51], s58 offen offset:0 sc1
    buffer_store_dwordx4 v[24:27], v148, s[48:51], s58 offen offset:1024 sc1
    s_mov_b64 exec, -1
    s_waitcnt lgkmcnt(0)
    v_pk_mul_f32 v[208:209], v[208:209], v[72:73] op_sel:[0,1]
    v_pk_mul_f32 v[210:211], v[210:211], v[72:73] op_sel:[0,1]
    v_pk_mul_f32 v[212:213], v[212:213], v[72:73] op_sel:[0,1]
    v_pk_mul_f32 v[214:215], v[214:215], v[72:73] op_sel:[0,1]
    v_pk_fma_f32 v[216:217], v[208:209], v[72:73], v[216:217] op_sel_hi:[1,0,1] neg_lo:[1,0,0] neg_hi:[1,0,0]
    v_pk_fma_f32 v[218:219], v[210:211], v[72:73], v[218:219] op_sel_hi:[1,0,1] neg_lo:[1,0,0] neg_hi:[1,0,0]
    v_pk_fma_f32 v[220:221], v[212:213], v[72:73], v[220:221] op_sel_hi:[1,0,1] neg_lo:[1,0,0] neg_hi:[1,0,0]
    v_pk_fma_f32 v[222:223], v[214:215], v[72:73], v[222:223] op_sel_hi:[1,0,1] neg_lo:[1,0,0] neg_hi:[1,0,0]
    v_pk_fma_f32 v[80:81], v[80:81], v[208:209], v[216:217]
    v_pk_fma_f32 v[82:83], v[82:83], v[210:211], v[218:219]
    v_pk_fma_f32 v[84:85], v[84:85], v[212:213], v[220:221]
    v_pk_fma_f32 v[86:87], v[86:87], v[214:215], v[222:223]
    v_exp_f32 v64, v80
    v_exp_f32 v65, v81
    v_exp_f32 v66, v82
    v_exp_f32 v67, v83
    v_exp_f32 v68, v84
    v_exp_f32 v69, v85
    v_exp_f32 v70, v86
    v_exp_f32 v71, v87
    s_mov_b64 exec, s[20:21]
    buffer_store_dwordx4 v[16:19], v148, s[48:51], s58 offen offset:2048 sc1
    buffer_store_dwordx4 v[56:59], v148, s[48:51], s59 offen offset:0 sc1
    s_mov_b64 exec, -1
    v_pk_fma_f32 v[64:65], v[64:65], s[52:53], s[52:53] op_sel:[0,1,1]
    v_pk_fma_f32 v[66:67], v[66:67], s[52:53], s[52:53] op_sel:[0,1,1]
    v_pk_fma_f32 v[68:69], v[68:69], s[52:53], s[52:53] op_sel:[0,1,1]
    v_pk_fma_f32 v[70:71], v[70:71], s[52:53], s[52:53] op_sel:[0,1,1]
    v_rcp_f32 v64, v64
    v_rcp_f32 v65, v65
    v_rcp_f32 v66, v66
    v_rcp_f32 v67, v67
    v_rcp_f32 v68, v68
    v_rcp_f32 v69, v69
    v_rcp_f32 v70, v70
    v_rcp_f32 v71, v71
    v_pk_mul_f32 v[80:81], v[80:81], v[64:65]
    v_pk_mul_f32 v[82:83], v[82:83], v[66:67]
    v_pk_mul_f32 v[84:85], v[84:85], v[68:69]
    v_pk_mul_f32 v[86:87], v[86:87], v[70:71]
    v_cvt_pk_f16_f32 v80, v80, v81
    v_cvt_pk_f16_f32 v81, v82, v83
    v_cvt_pk_f16_f32 v82, v84, v85
    v_cvt_pk_f16_f32 v83, v86, v87
    buffer_store_dwordx4 v[80:83], v9, s[12:15], s29 offen offset:0 sc1
    v_pk_fma_f32 v[88:89], v[88:89], v[208:209], v[216:217]
    v_pk_fma_f32 v[90:91], v[90:91], v[210:211], v[218:219]
    v_pk_fma_f32 v[92:93], v[92:93], v[212:213], v[220:221]
    v_pk_fma_f32 v[94:95], v[94:95], v[214:215], v[222:223]
    v_exp_f32 v64, v88
    v_exp_f32 v65, v89
    v_exp_f32 v66, v90
    v_exp_f32 v67, v91
    v_exp_f32 v68, v92
    v_exp_f32 v69, v93
    v_exp_f32 v70, v94
    v_exp_f32 v71, v95
    s_mov_b64 exec, s[20:21]
    buffer_store_dwordx4 v[48:51], v148, s[48:51], s59 offen offset:1024 sc1
    buffer_store_dwordx4 v[40:43], v148, s[48:51], s59 offen offset:2048 sc1
    s_mov_b64 exec, -1
    v_pk_fma_f32 v[64:65], v[64:65], s[52:53], s[52:53] op_sel:[0,1,1]
    v_pk_fma_f32 v[66:67], v[66:67], s[52:53], s[52:53] op_sel:[0,1,1]
    v_pk_fma_f32 v[68:69], v[68:69], s[52:53], s[52:53] op_sel:[0,1,1]
    v_pk_fma_f32 v[70:71], v[70:71], s[52:53], s[52:53] op_sel:[0,1,1]
    v_rcp_f32 v64, v64
    v_rcp_f32 v65, v65
    v_rcp_f32 v66, v66
    v_rcp_f32 v67, v67
    v_rcp_f32 v68, v68
    v_rcp_f32 v69, v69
    v_rcp_f32 v70, v70
    v_rcp_f32 v71, v71
    v_pk_mul_f32 v[88:89], v[88:89], v[64:65]
    v_pk_mul_f32 v[90:91], v[90:91], v[66:67]
    v_pk_mul_f32 v[92:93], v[92:93], v[68:69]
    v_pk_mul_f32 v[94:95], v[94:95], v[70:71]
    v_cvt_pk_f16_f32 v88, v88, v89
    v_cvt_pk_f16_f32 v89, v90, v91
    v_cvt_pk_f16_f32 v90, v92, v93
    v_cvt_pk_f16_f32 v91, v94, v95
    buffer_store_dwordx4 v[88:91], v9, s[12:15], s29 offen offset:1024 sc1
    v_pk_fma_f32 v[96:97], v[96:97], v[208:209], v[216:217]
    v_pk_fma_f32 v[98:99], v[98:99], v[210:211], v[218:219]
    v_pk_fma_f32 v[100:101], v[100:101], v[212:213], v[220:221]
    v_pk_fma_f32 v[102:103], v[102:103], v[214:215], v[222:223]
    v_exp_f32 v64, v96
    v_exp_f32 v65, v97
    v_exp_f32 v66, v98
    v_exp_f32 v67, v99
    v_exp_f32 v68, v100
    v_exp_f32 v69, v101
    v_exp_f32 v70, v102
    v_exp_f32 v71, v103
    v_pk_fma_f32 v[64:65], v[64:65], s[52:53], s[52:53] op_sel:[0,1,1]
    v_pk_fma_f32 v[66:67], v[66:67], s[52:53], s[52:53] op_sel:[0,1,1]
    v_pk_fma_f32 v[68:69], v[68:69], s[52:53], s[52:53] op_sel:[0,1,1]
    v_pk_fma_f32 v[70:71], v[70:71], s[52:53], s[52:53] op_sel:[0,1,1]
    v_rcp_f32 v64, v64
    v_rcp_f32 v65, v65
    v_rcp_f32 v66, v66
    v_rcp_f32 v67, v67
    v_rcp_f32 v68, v68
    v_rcp_f32 v69, v69
    v_rcp_f32 v70, v70
    v_rcp_f32 v71, v71
    v_pk_mul_f32 v[96:97], v[96:97], v[64:65]
    v_pk_mul_f32 v[98:99], v[98:99], v[66:67]
    v_pk_mul_f32 v[100:101], v[100:101], v[68:69]
    v_pk_mul_f32 v[102:103], v[102:103], v[70:71]
    v_cvt_pk_f16_f32 v96, v96, v97
    v_cvt_pk_f16_f32 v97, v98, v99
    v_cvt_pk_f16_f32 v98, v100, v101
    v_cvt_pk_f16_f32 v99, v102, v103
    buffer_store_dwordx4 v[96:99], v9, s[12:15], s29 offen offset:2048 sc1
    v_pk_fma_f32 v[104:105], v[104:105], v[208:209], v[216:217]
    v_pk_fma_f32 v[106:107], v[106:107], v[210:211], v[218:219]
    v_pk_fma_f32 v[108:109], v[108:109], v[212:213], v[220:221]
    v_pk_fma_f32 v[110:111], v[110:111], v[214:215], v[222:223]
    v_exp_f32 v64, v104
    v_exp_f32 v65, v105
    v_exp_f32 v66, v106
    v_exp_f32 v67, v107
    v_exp_f32 v68, v108
    v_exp_f32 v69, v109
    v_exp_f32 v70, v110
    v_exp_f32 v71, v111
    v_pk_fma_f32 v[64:65], v[64:65], s[52:53], s[52:53] op_sel:[0,1,1]
    v_pk_fma_f32 v[66:67], v[66:67], s[52:53], s[52:53] op_sel:[0,1,1]
    v_pk_fma_f32 v[68:69], v[68:69], s[52:53], s[52:53] op_sel:[0,1,1]
    v_pk_fma_f32 v[70:71], v[70:71], s[52:53], s[52:53] op_sel:[0,1,1]
    v_rcp_f32 v64, v64
    v_rcp_f32 v65, v65
    v_rcp_f32 v66, v66
    v_rcp_f32 v67, v67
    v_rcp_f32 v68, v68
    v_rcp_f32 v69, v69
    v_rcp_f32 v70, v70
    v_rcp_f32 v71, v71
    v_pk_mul_f32 v[104:105], v[104:105], v[64:65]
    v_pk_mul_f32 v[106:107], v[106:107], v[66:67]
    v_pk_mul_f32 v[108:109], v[108:109], v[68:69]
    v_pk_mul_f32 v[110:111], v[110:111], v[70:71]
    v_cvt_pk_f16_f32 v104, v104, v105
    v_cvt_pk_f16_f32 v105, v106, v107
    v_cvt_pk_f16_f32 v106, v108, v109
    v_cvt_pk_f16_f32 v107, v110, v111
    buffer_store_dwordx4 v[104:107], v9, s[12:15], s29 offen offset:3072 sc1
    v_pk_fma_f32 v[176:177], v[176:177], v[208:209], v[216:217]
    v_pk_fma_f32 v[178:179], v[178:179], v[210:211], v[218:219]
    v_pk_fma_f32 v[180:181], v[180:181], v[212:213], v[220:221]
    v_pk_fma_f32 v[182:183], v[182:183], v[214:215], v[222:223]
    v_exp_f32 v64, v176
    v_exp_f32 v65, v177
    v_exp_f32 v66, v178
    v_exp_f32 v67, v179
    v_exp_f32 v68, v180
    v_exp_f32 v69, v181
    v_exp_f32 v70, v182
    v_exp_f32 v71, v183
    v_pk_fma_f32 v[64:65], v[64:65], s[52:53], s[52:53] op_sel:[0,1,1]
    v_pk_fma_f32 v[66:67], v[66:67], s[52:53], s[52:53] op_sel:[0,1,1]
    v_pk_fma_f32 v[68:69], v[68:69], s[52:53], s[52:53] op_sel:[0,1,1]
    v_pk_fma_f32 v[70:71], v[70:71], s[52:53], s[52:53] op_sel:[0,1,1]
    v_rcp_f32 v64, v64
    v_rcp_f32 v65, v65
    v_rcp_f32 v66, v66
    v_rcp_f32 v67, v67
    v_rcp_f32 v68, v68
    v_rcp_f32 v69, v69
    v_rcp_f32 v70, v70
    v_rcp_f32 v71, v71
    v_pk_mul_f32 v[176:177], v[176:177], v[64:65]
    v_pk_mul_f32 v[178:179], v[178:179], v[66:67]
    v_pk_mul_f32 v[180:181], v[180:181], v[68:69]
    v_pk_mul_f32 v[182:183], v[182:183], v[70:71]
    v_cvt_pk_f16_f32 v176, v176, v177
    v_cvt_pk_f16_f32 v177, v178, v179
    v_cvt_pk_f16_f32 v178, v180, v181
    v_cvt_pk_f16_f32 v179, v182, v183
    buffer_store_dwordx4 v[176:179], v9, s[12:15], s30 offen offset:0 sc1
    v_pk_fma_f32 v[184:185], v[184:185], v[208:209], v[216:217]
    v_pk_fma_f32 v[186:187], v[186:187], v[210:211], v[218:219]
    v_pk_fma_f32 v[188:189], v[188:189], v[212:213], v[220:221]
    v_pk_fma_f32 v[190:191], v[190:191], v[214:215], v[222:223]
    v_exp_f32 v64, v184
    v_exp_f32 v65, v185
    v_exp_f32 v66, v186
    v_exp_f32 v67, v187
    v_exp_f32 v68, v188
    v_exp_f32 v69, v189
    v_exp_f32 v70, v190
    v_exp_f32 v71, v191
    v_pk_fma_f32 v[64:65], v[64:65], s[52:53], s[52:53] op_sel:[0,1,1]
    v_pk_fma_f32 v[66:67], v[66:67], s[52:53], s[52:53] op_sel:[0,1,1]
    v_pk_fma_f32 v[68:69], v[68:69], s[52:53], s[52:53] op_sel:[0,1,1]
    v_pk_fma_f32 v[70:71], v[70:71], s[52:53], s[52:53] op_sel:[0,1,1]
    v_rcp_f32 v64, v64
    v_rcp_f32 v65, v65
    v_rcp_f32 v66, v66
    v_rcp_f32 v67, v67
    v_rcp_f32 v68, v68
    v_rcp_f32 v69, v69
    v_rcp_f32 v70, v70
    v_rcp_f32 v71, v71
    v_pk_mul_f32 v[184:185], v[184:185], v[64:65]
    v_pk_mul_f32 v[186:187], v[186:187], v[66:67]
    v_pk_mul_f32 v[188:189], v[188:189], v[68:69]
    v_pk_mul_f32 v[190:191], v[190:191], v[70:71]
    v_cvt_pk_f16_f32 v184, v184, v185
    v_cvt_pk_f16_f32 v185, v186, v187
    v_cvt_pk_f16_f32 v186, v188, v189
    v_cvt_pk_f16_f32 v187, v190, v191
    buffer_store_dwordx4 v[184:187], v9, s[12:15], s30 offen offset:1024 sc1
    v_pk_fma_f32 v[192:193], v[192:193], v[208:209], v[216:217]
    v_pk_fma_f32 v[194:195], v[194:195], v[210:211], v[218:219]
    v_pk_fma_f32 v[196:197], v[196:197], v[212:213], v[220:221]
    v_pk_fma_f32 v[198:199], v[198:199], v[214:215], v[222:223]
    v_exp_f32 v64, v192
    v_exp_f32 v65, v193
    v_exp_f32 v66, v194
    v_exp_f32 v67, v195
    v_exp_f32 v68, v196
    v_exp_f32 v69, v197
    v_exp_f32 v70, v198
    v_exp_f32 v71, v199
    v_pk_fma_f32 v[64:65], v[64:65], s[52:53], s[52:53] op_sel:[0,1,1]
    v_pk_fma_f32 v[66:67], v[66:67], s[52:53], s[52:53] op_sel:[0,1,1]
    v_pk_fma_f32 v[68:69], v[68:69], s[52:53], s[52:53] op_sel:[0,1,1]
    v_pk_fma_f32 v[70:71], v[70:71], s[52:53], s[52:53] op_sel:[0,1,1]
    v_rcp_f32 v64, v64
    v_rcp_f32 v65, v65
    v_rcp_f32 v66, v66
    v_rcp_f32 v67, v67
    v_rcp_f32 v68, v68
    v_rcp_f32 v69, v69
    v_rcp_f32 v70, v70
    v_rcp_f32 v71, v71
    v_pk_mul_f32 v[192:193], v[192:193], v[64:65]
    v_pk_mul_f32 v[194:195], v[194:195], v[66:67]
    v_pk_mul_f32 v[196:197], v[196:197], v[68:69]
    v_pk_mul_f32 v[198:199], v[198:199], v[70:71]
    v_cvt_pk_f16_f32 v192, v192, v193
    v_cvt_pk_f16_f32 v193, v194, v195
    v_cvt_pk_f16_f32 v194, v196, v197
    v_cvt_pk_f16_f32 v195, v198, v199
    buffer_store_dwordx4 v[192:195], v9, s[12:15], s30 offen offset:2048 sc1
    v_pk_fma_f32 v[200:201], v[200:201], v[208:209], v[216:217]
    v_pk_fma_f32 v[202:203], v[202:203], v[210:211], v[218:219]
    v_pk_fma_f32 v[204:205], v[204:205], v[212:213], v[220:221]
    v_pk_fma_f32 v[206:207], v[206:207], v[214:215], v[222:223]
    v_exp_f32 v64, v200
    v_exp_f32 v65, v201
    v_exp_f32 v66, v202
    v_exp_f32 v67, v203
    v_exp_f32 v68, v204
    v_exp_f32 v69, v205
    v_exp_f32 v70, v206
    v_exp_f32 v71, v207
    v_pk_fma_f32 v[64:65], v[64:65], s[52:53], s[52:53] op_sel:[0,1,1]
    v_pk_fma_f32 v[66:67], v[66:67], s[52:53], s[52:53] op_sel:[0,1,1]
    v_pk_fma_f32 v[68:69], v[68:69], s[52:53], s[52:53] op_sel:[0,1,1]
    v_pk_fma_f32 v[70:71], v[70:71], s[52:53], s[52:53] op_sel:[0,1,1]
    v_rcp_f32 v64, v64
    v_rcp_f32 v65, v65
    v_rcp_f32 v66, v66
    v_rcp_f32 v67, v67
    v_rcp_f32 v68, v68
    v_rcp_f32 v69, v69
    v_rcp_f32 v70, v70
    v_rcp_f32 v71, v71
    v_pk_mul_f32 v[200:201], v[200:201], v[64:65]
    v_pk_mul_f32 v[202:203], v[202:203], v[66:67]
    v_pk_mul_f32 v[204:205], v[204:205], v[68:69]
    v_pk_mul_f32 v[206:207], v[206:207], v[70:71]
    v_cvt_pk_f16_f32 v200, v200, v201
    v_cvt_pk_f16_f32 v201, v202, v203
    v_cvt_pk_f16_f32 v202, v204, v205
    v_cvt_pk_f16_f32 v203, v206, v207
    buffer_store_dwordx4 v[200:203], v9, s[12:15], s30 offen offset:3072 sc1
    s_not_b64 s[20:21], s[20:21]
    v_add_u32 v78, s78, v9
    v_add_u32_e64 v79, s79, v9
    ds_write_b128 v78, v[80:83] offset:0
    ds_write_b128 v78, v[88:91] offset:1024
    ds_write_b128 v78, v[96:99] offset:2048
    ds_write_b128 v78, v[104:107] offset:3072
    ds_write_b128 v79, v[176:179] offset:0
    ds_write_b128 v79, v[184:187] offset:1024
    ds_write_b128 v79, v[192:195] offset:2048
    ds_write_b128 v79, v[200:203] offset:3072
    s_waitcnt vmcnt(4)
    s_barrier
    v_mov_b32 v76, 1
    s_mov_b64 exec, 1
    buffer_store_dword v76, v9, s[16:19], s71 offen offset:8 sc1
    s_mov_b64 exec, -1
    v_cmp_ne_u32 vcc, s47, v75
    s_nop 1
    v_mov_b32 v74, vcc_lo
    ds_write_b32 v149, v74
    s_waitcnt vmcnt(10)
    v_and_b32 v114, v114, v118
    v_cmp_ne_u32 vcc, 1, v114
    s_nop 0
    s_cmp_lg_u64 vcc, 0
    s_cbranch_scc1 L_masks_slow
L_masks_out:
    v_lshrrev_b32 v113, 10, v11
    v_lshrrev_b32 v113, v113, v112
    v_and_b32_e64 v113, 1, v113
    v_cmp_eq_u32 s[74:75], 1, v113
    v_lshrrev_b32 v113, 10, v14
    v_lshrrev_b32 v113, v113, v116
    v_and_b32_e64 v113, 1, v113
    v_cmp_eq_u32 s[76:77], 1, v113
    s_lshl_b32 s70, s3, 10
    v_and_b32 v151, 48, v9
    v_mul_u32_u24 v151, 580, v151
    v_bfe_u32 v150, v9, 6, 2
    v_mul_u32_u24 v150, 144, v150
    s_mul_i32 s37, s3, 576
    s_add_u32 s37, s37, 51200
    v_add3_u32 v151, v151, v150, s37
    v_and_b32 v150, 0x300, v9
    v_mad_u32_u24 v151, v150, 9, v151
    ds_read_b128 v[112:115], v151 offset:0
    ds_read_b128 v[116:119], v151 offset:16
    ds_read_b128 v[120:123], v151 offset:32
    ds_read_b128 v[124:127], v151 offset:48
    ds_read_b128 v[128:131], v151 offset:64
    ds_read_b128 v[132:135], v151 offset:80
    ds_read_b128 v[136:139], v151 offset:96
    ds_read_b128 v[140:143], v151 offset:112
    ds_read_b128 v[144:147], v151 offset:128
    s_mov_b64 exec, s[20:21]
    buffer_store_dwordx4 v[32:35], v148, s[48:51], s58 offen offset:0 sc1
    s_mov_b64 exec, -1
    v_mov_b32 v150, 0
    s_cmp_eq_u32 s31, 0
    s_cselect_b32 s38, 1.0, -1.0
    s_lshl2_add_u32 s37, s3, 160000
    v_mov_b32 v151, s37
    s_waitcnt lgkmcnt(7)
    v_lshlrev_b32 v176, 16, v112
    v_and_b32 v184, s88, v112
    s_mov_b64 exec, s[20:21]
    buffer_store_dwordx4 v[24:27], v148, s[48:51], s58 offen offset:1024 sc1
    s_mov_b64 exec, -1
    v_max3_f32 v150, abs(v176), abs(v184), v150
    v_lshlrev_b32 v192, 16, v113
    v_and_b32_e64 v200, s88, v113
    v_max3_f32 v150, abs(v192), abs(v200), v150
    v_lshlrev_b32 v208, 16, v114
    v_and_b32 v216, s88, v114
    v_max3_f32 v150, abs(v208), abs(v216), v150
    v_lshlrev_b32 v152, 16, v115
    s_mov_b64 exec, s[20:21]
    buffer_store_dwordx4 v[16:19], v148, s[48:51], s58 offen offset:2048 sc1
    s_mov_b64 exec, -1
    v_and_b32 v160, s88, v115
    v_max3_f32 v150, abs(v152), abs(v160), v150
    v_lshlrev_b32 v168, 16, v116
    v_and_b32 v177, s88, v116
    v_max3_f32 v150, abs(v168), abs(v177), v150
    v_lshlrev_b32 v185, 16, v117
    v_and_b32 v193, s88, v117
    v_max3_f32 v150, abs(v185), abs(v193), v150
    s_mov_b64 exec, s[20:21]
    buffer_store_dwordx4 v[56:59], v148, s[48:51], s59 offen offset:0 sc1
    s_mov_b64 exec, -1
    v_lshlrev_b32 v201, 16, v118
    v_and_b32 v209, s88, v118
    v_max3_f32 v150, abs(v201), abs(v209), v150
    v_lshlrev_b32 v217, 16, v119
    v_and_b32 v153, s88, v119
    v_max3_f32 v150, abs(v217), abs(v153), v150
    s_waitcnt lgkmcnt(5)
    v_lshlrev_b32 v161, 16, v120
    s_mov_b64 exec, s[20:21]
    buffer_store_dwordx4 v[48:51], v148, s[48:51], s59 offen offset:1024 sc1
    s_mov_b64 exec, -1
    v_and_b32_e64 v169, s88, v120
    v_max3_f32 v150, abs(v161), abs(v169), v150
    v_lshlrev_b32 v178, 16, v121
    v_and_b32 v186, s88, v121
    v_max3_f32 v150, abs(v178), abs(v186), v150
    v_lshlrev_b32 v194, 16, v122
    v_and_b32 v202, s88, v122
    v_max3_f32 v150, abs(v194), abs(v202), v150
    s_mov_b64 exec, s[20:21]
    buffer_store_dwordx4 v[40:43], v148, s[48:51], s59 offen offset:2048 sc1
    s_mov_b64 exec, -1
    v_lshlrev_b32 v210, 16, v123
    v_and_b32 v218, s88, v123
    v_max3_f32 v150, abs(v210), abs(v218), v150
    v_lshlrev_b32 v154, 16, v124
    v_and_b32 v162, s88, v124
    v_max3_f32 v150, abs(v154), abs(v162), v150
    v_lshlrev_b32 v170, 16, v125
    v_and_b32 v179, s88, v125
    v_max3_f32 v150, abs(v170), abs(v179), v150
    v_lshlrev_b32 v187, 16, v126
    v_and_b32 v195, s88, v126
    v_max3_f32 v150, abs(v187), abs(v195), v150
    v_lshlrev_b32 v203, 16, v127
    v_and_b32 v211, s88, v127
    v_max3_f32 v150, abs(v203), abs(v211), v150
    s_waitcnt lgkmcnt(3)
    v_lshlrev_b32 v219, 16, v128
    v_and_b32_e64 v155, s88, v128
    v_max3_f32 v150, abs(v219), abs(v155), v150
    v_lshlrev_b32 v163, 16, v129
    v_and_b32 v171, s88, v129
    v_max3_f32 v150, abs(v163), abs(v171), v150
    v_lshlrev_b32 v180, 16, v130
    v_and_b32 v188, s88, v130
    v_max3_f32 v150, abs(v180), abs(v188), v150
    v_lshlrev_b32 v196, 16, v131
    v_and_b32 v204, s88, v131
    v_max3_f32 v150, abs(v196), abs(v204), v150
    v_lshlrev_b32 v212, 16, v132
    v_and_b32 v220, s88, v132
    v_max3_f32 v150, abs(v212), abs(v220), v150
    v_lshlrev_b32 v156, 16, v133
    v_and_b32 v164, s88, v133
    v_max3_f32 v150, abs(v156), abs(v164), v150
    v_lshlrev_b32 v172, 16, v134
    v_and_b32 v181, s88, v134
    v_max3_f32 v150, abs(v172), abs(v181), v150
    v_lshlrev_b32 v189, 16, v135
    v_and_b32 v197, s88, v135
    v_max3_f32 v150, abs(v189), abs(v197), v150
    s_waitcnt lgkmcnt(1)
    v_lshlrev_b32 v205, 16, v136
    v_and_b32_e64 v213, s88, v136
    v_max3_f32 v150, abs(v205), abs(v213), v150
    v_lshlrev_b32 v221, 16, v137
    v_and_b32 v157, s88, v137
    v_max3_f32 v150, abs(v221), abs(v157), v150
    v_lshlrev_b32 v165, 16, v138
    v_and_b32 v173, s88, v138
    v_max3_f32 v150, abs(v165), abs(v173), v150
    v_lshlrev_b32 v182, 16, v139
    v_and_b32 v190, s88, v139
    v_max3_f32 v150, abs(v182), abs(v190), v150
    v_lshlrev_b32 v198, 16, v140
    v_and_b32 v206, s88, v140
    v_max3_f32 v150, abs(v198), abs(v206), v150
    v_lshlrev_b32 v214, 16, v141
    v_and_b32 v222, s88, v141
    v_max3_f32 v150, abs(v214), abs(v222), v150
    v_lshlrev_b32 v158, 16, v142
    v_and_b32 v166, s88, v142
    v_max3_f32 v150, abs(v158), abs(v166), v150
    v_lshlrev_b32 v174, 16, v143
    v_and_b32 v183, s88, v143
    v_max3_f32 v150, abs(v174), abs(v183), v150
    s_waitcnt lgkmcnt(0)
    v_lshlrev_b32 v191, 16, v144
    v_and_b32_e64 v199, s88, v144
    v_max3_f32 v150, abs(v191), abs(v199), v150
    v_lshlrev_b32 v207, 16, v145
    v_and_b32 v215, s88, v145
    v_max3_f32 v150, abs(v207), abs(v215), v150
    v_lshlrev_b32 v223, 16, v146
    v_and_b32 v159, s88, v146
    v_max3_f32 v150, abs(v223), abs(v159), v150
    v_lshlrev_b32 v167, 16, v147
    v_and_b32 v175, s88, v147
    v_max3_f32 v150, abs(v167), abs(v175), v150
    v_pk_fma_f32 v[200:201], v[200:201], s[38:39], v[176:177] op_sel_hi:[1,0,1]
    v_pk_fma_f32 v[202:203], v[202:203], s[38:39], v[178:179] op_sel_hi:[1,0,1]
    v_pk_fma_f32 v[204:205], v[204:205], s[38:39], v[180:181] op_sel_hi:[1,0,1]
    v_max_u32_dpp v150, v150, v150 row_shr:1 row_mask:0xf bank_mask:0xf bound_ctrl:1
    v_pk_fma_f32 v[206:207], v[206:207], s[38:39], v[182:183] op_sel_hi:[1,0,1]
    v_pk_fma_f32 v[208:209], v[208:209], s[38:39], v[184:185] op_sel_hi:[1,0,1]
    v_pk_fma_f32 v[210:211], v[210:211], s[38:39], v[186:187] op_sel_hi:[1,0,1]
    v_max_u32_dpp v150, v150, v150 row_shr:2 row_mask:0xf bank_mask:0xf bound_ctrl:1
    v_pk_fma_f32 v[212:213], v[212:213], s[38:39], v[188:189] op_sel_hi:[1,0,1]
    v_pk_fma_f32 v[214:215], v[214:215], s[38:39], v[190:191] op_sel_hi:[1,0,1]
    v_pk_fma_f32 v[216:217], v[216:217], s[38:39], v[192:193] op_sel_hi:[1,0,1]
    v_max_u32_dpp v150, v150, v150 row_shr:4 row_mask:0xf bank_mask:0xf bound_ctrl:1
    v_pk_fma_f32 v[218:219], v[218:219], s[38:39], v[194:195] op_sel_hi:[1,0,1]
    v_pk_fma_f32 v[220:221], v[220:221], s[38:39], v[196:197] op_sel_hi:[1,0,1]
    v_pk_fma_f32 v[222:223], v[222:223], s[38:39], v[198:199] op_sel_hi:[1,0,1]
    v_max_u32_dpp v150, v150, v150 row_shr:8 row_mask:0xf bank_mask:0xf bound_ctrl:1
    v_pk_add_f32 v[200:201], v[200:201], v[152:153]
    v_pk_add_f32 v[202:203], v[202:203], v[154:155]
    v_pk_add_f32 v[204:205], v[204:205], v[156:157]
    v_max_u32_dpp v150, v150, v150 row_bcast:15 row_mask:0xa bank_mask:0xf
    v_pk_add_f32 v[206:207], v[206:207], v[158:159]
    v_pk_add_f32 v[208:209], v[208:209], v[160:161]
    v_pk_add_f32 v[210:211], v[210:211], v[162:163]
    v_max_u32_dpp v150, v150, v150 row_bcast:31 row_mask:0xc bank_mask:0xf
    s_lshl_b64 exec, 1, 63
    ds_write_b32 v151, v150
    s_mov_b64 exec, -1
    v_mov_b32 v151, 160000
    v_pk_add_f32 v[212:213], v[212:213], v[164:165]
    v_pk_add_f32 v[214:215], v[214:215], v[166:167]
    v_pk_add_f32 v[216:217], v[216:217], v[168:169]
    v_pk_add_f32 v[218:219], v[218:219], v[170:171]
    v_pk_add_f32 v[220:221], v[220:221], v[172:173]
    v_pk_add_f32 v[222:223], v[222:223], v[174:175]
    s_cmp_lg_u32 s31, 0
    s_cbranch_scc1 L_else7
    v_pk_add_f32 v[64:65], v[184:185], v[192:193]
    v_pk_add_f32 v[66:67], v[186:187], v[194:195]
    v_pk_add_f32 v[68:69], v[188:189], v[196:197]
    v_pk_add_f32 v[70:71], v[190:191], v[198:199]
    v_pk_add_f32 v[184:185], v[176:177], v[64:65]
    v_pk_add_f32 v[186:187], v[178:179], v[66:67]
    v_pk_add_f32 v[188:189], v[180:181], v[68:69]
    v_pk_add_f32 v[190:191], v[182:183], v[70:71]
    v_pk_add_f32 v[176:177], v[176:177], v[64:65] neg_lo:[0,1] neg_hi:[0,1]
    v_pk_add_f32 v[178:179], v[178:179], v[66:67] neg_lo:[0,1] neg_hi:[0,1]
    v_pk_add_f32 v[180:181], v[180:181], v[68:69] neg_lo:[0,1] neg_hi:[0,1]
    v_pk_add_f32 v[182:183], v[182:183], v[70:71] neg_lo:[0,1] neg_hi:[0,1]
    s_branch L_fi7
    s_nop 0
L_else7:
    v_pk_add_f32 v[64:65], v[160:161], v[168:169]
    v_pk_add_f32 v[66:67], v[162:163], v[170:171]
    v_pk_add_f32 v[68:69], v[164:165], v[172:173]
    v_pk_add_f32 v[70:71], v[166:167], v[174:175]
    v_pk_mov_b32 v[192:193], v[168:169], v[168:169] op_sel:[0,1]
    v_pk_mov_b32 v[194:195], v[170:171], v[170:171] op_sel:[0,1]
    v_pk_mov_b32 v[196:197], v[172:173], v[172:173] op_sel:[0,1]
    v_pk_mov_b32 v[198:199], v[174:175], v[174:175] op_sel:[0,1]
    v_pk_add_f32 v[184:185], v[152:153], v[64:65]
    v_pk_add_f32 v[186:187], v[154:155], v[66:67]
    v_pk_add_f32 v[188:189], v[156:157], v[68:69]
    v_pk_add_f32 v[190:191], v[158:159], v[70:71]
    v_pk_add_f32 v[176:177], v[152:153], v[64:65] neg_lo:[0,1] neg_hi:[0,1]
    v_pk_add_f32 v[178:179], v[154:155], v[66:67] neg_lo:[0,1] neg_hi:[0,1]
    v_pk_add_f32 v[180:181], v[156:157], v[68:69] neg_lo:[0,1] neg_hi:[0,1]
    v_pk_add_f32 v[182:183], v[158:159], v[70:71] neg_lo:[0,1] neg_hi:[0,1]
L_fi7:
    s_waitcnt lgkmcnt(0)
    s_barrier
    ds_read_b32 v77, v77
    ds_read_b128 v[112:115], v151
    v_pk_add_f32 v[64:65], v[208:209], v[216:217]
    v_pk_add_f32 v[66:67], v[210:211], v[218:219]
    v_pk_add_f32 v[68:69], v[212:213], v[220:221]
    v_pk_add_f32 v[70:71], v[214:215], v[222:223]
    v_pk_add_f32 v[208:209], v[200:201], v[64:65]
    v_pk_add_f32 v[210:211], v[202:203], v[66:67]
    v_pk_add_f32 v[212:213], v[204:205], v[68:69]
    v_pk_add_f32 v[214:215], v[206:207], v[70:71]
    v_pk_add_f32 v[200:201], v[200:201], v[64:65] neg_lo:[0,1] neg_hi:[0,1]
    buffer_load_dwordx4 v[72:75], v11, s[16:19], s45 offen sc1
    v_pk_add_f32 v[202:203], v[202:203], v[66:67] neg_lo:[0,1] neg_hi:[0,1]
    v_pk_add_f32 v[204:205], v[204:205], v[68:69] neg_lo:[0,1] neg_hi:[0,1]
    v_pk_add_f32 v[206:207], v[206:207], v[70:71] neg_lo:[0,1] neg_hi:[0,1]
    s_waitcnt lgkmcnt(0)
    v_max3_f32 v150, v112, v113, v114
    v_max_f32 v150, v150, v115
    v_frexp_exp_i32_f32 v150, v150
    s_nop 0
    v_readfirstlane_b32 s39, v150
    s_nop 0
    s_max_i32 s39, s39, -100
    s_min_i32 s39, s39, 128
    s_sub_i32 s80, 140, s39
    s_lshl_b32 s80, s80, 23
    s_sub_u32 s81, s80, 0x800000
    s_sub_u32 s82, s80, 0x1000000
    s_add_i32 s39, s39, 114
    s_lshl_b32 s39, s39, 23
    v_pk_mul_f32 v[192:193], v[192:193], s[80:81] op_sel_hi:[1,0]
    v_pk_mul_f32 v[194:195], v[194:195], s[80:81] op_sel_hi:[1,0]
    v_pk_mul_f32 v[196:197], v[196:197], s[80:81] op_sel_hi:[1,0]
    v_pk_mul_f32 v[198:199], v[198:199], s[80:81] op_sel_hi:[1,0]
    v_pk_mul_f32 v[184:185], v[184:185], s[80:81] op_sel:[0,1]
    v_pk_mul_f32 v[186:187], v[186:187], s[80:81] op_sel:[0,1]
    v_pk_mul_f32 v[188:189], v[188:189], s[80:81] op_sel:[0,1]
    v_pk_mul_f32 v[190:191], v[190:191], s[80:81] op_sel:[0,1]
    v_pk_mul_f32 v[176:177], v[176:177], s[80:81] op_sel:[0,1]
    v_pk_mul_f32 v[178:179], v[178:179], s[80:81] op_sel:[0,1]
    v_pk_mul_f32 v[180:181], v[180:181], s[80:81] op_sel:[0,1]
    v_pk_mul_f32 v[182:183], v[182:183], s[80:81] op_sel:[0,1]
    v_pk_mul_f32 v[216:217], v[216:217], s[80:81] op_sel:[0,1]
    v_pk_mul_f32 v[218:219], v[218:219], s[80:81] op_sel:[0,1]
    v_pk_mul_f32 v[220:221], v[220:221], s[80:81] op_sel:[0,1]
    v_pk_mul_f32 v[222:223], v[222:223], s[80:81] op_sel:[0,1]
    v_pk_mul_f32 v[208:209], v[208:209], s[82:83] op_sel_hi:[1,0]
    v_pk_mul_f32 v[210:211], v[210:211], s[82:83] op_sel_hi:[1,0]
    v_pk_mul_f32 v[212:213], v[212:213], s[82:83] op_sel_hi:[1,0]
    v_pk_mul_f32 v[214:215], v[214:215], s[82:83] op_sel_hi:[1,0]
    v_pk_mul_f32 v[200:201], v[200:201], s[82:83] op_sel_hi:[1,0]
    v_pk_mul_f32 v[202:203], v[202:203], s[82:83] op_sel_hi:[1,0]
    v_pk_mul_f32 v[204:205], v[204:205], s[82:83] op_sel_hi:[1,0]
    v_pk_mul_f32 v[206:207], v[206:207], s[82:83] op_sel_hi:[1,0]
    v_cvt_pk_f16_f32 v192, v192, v193
    v_cvt_pk_f16_f32 v193, v194, v195
    v_cvt_pk_f16_f32 v194, v196, v197
    v_cvt_pk_f16_f32 v195, v198, v199
    v_cvt_pk_f16_f32 v184, v184, v185
    v_cvt_pk_f16_f32 v185, v186, v187
    v_cvt_pk_f16_f32 v186, v188, v189
    v_cvt_pk_f16_f32 v187, v190, v191
    v_cvt_pk_f16_f32 v176, v176, v177
    v_cvt_pk_f16_f32 v177, v178, v179
    v_cvt_pk_f16_f32 v178, v180, v181
    v_cvt_pk_f16_f32 v179, v182, v183
    v_cvt_pk_f16_f32 v216, v216, v217
    v_cvt_pk_f16_f32 v217, v218, v219
    v_cvt_pk_f16_f32 v218, v220, v221
    v_cvt_pk_f16_f32 v219, v222, v223
    v_cvt_pk_f16_f32 v208, v208, v209
    v_cvt_pk_f16_f32 v209, v210, v211
    v_cvt_pk_f16_f32 v210, v212, v213
    v_cvt_pk_f16_f32 v211, v214, v215
    v_cvt_pk_f16_f32 v200, v200, v201
    v_cvt_pk_f16_f32 v201, v202, v203
    v_cvt_pk_f16_f32 v202, v204, v205
    v_cvt_pk_f16_f32 v203, v206, v207
    v_add_u32 v53, s83, v9
    v_add_u32 v54, s69, v9
    s_mov_b64 exec, 0
    s_cmp_eq_u32 s3, 0
    s_cbranch_scc1 L_pad0
    s_cmp_eq_u32 s3, 1
    s_cbranch_scc1 L_pad1
    s_cmp_eq_u32 s3, 2
    s_cbranch_scc1 L_pad2
    s_branch L_pad3
L_back:
    s_mov_b64 exec, -1
    s_waitcnt vmcnt(0)
    v_lshrrev_b32 v150, 2, v9
    v_mov_b32 v151, s39
    s_mov_b64 exec, 15
    buffer_store_dword v151, v150, s[16:19], s68 offen offset:2048 sc1
    s_mov_b64 exec, -1
    v_cmp_gt_i32_e64 vcc, 0, v73
    v_cmp_gt_u32 s[38:39], 1, v74
    s_xor_b64 vcc, vcc, s[74:75]
    s_or_b64 vcc, vcc, s[38:39]
    s_and_b64 vcc, vcc, s[22:23]
    s_cbranch_scc1 L_polle0_slow
L_polle0_out:
    s_barrier
    v_mov_b32 v76, 2
    s_mov_b64 exec, 1
    buffer_store_dword v76, v9, s[16:19], s71 offen offset:8 sc1
    s_mov_b64 exec, -1
    s_and_b32 s86, s85, 15
    s_add_u32 m0, s70, 24576
    s_nop 0
    buffer_load_dwordx4 v53, s[8:11], s41 offen sc1 lds
    s_add_u32 m0, s70, 45056
    s_nop 0
    buffer_load_dwordx4 v54, s[8:11], s41 offen sc1 lds
    s_add_u32 m0, s70, 0
    s_add_u32 s41, s41, 0x40000
    buffer_load_dwordx4 v53, s[8:11], s41 offen sc1 lds
    s_add_u32 m0, s70, 20480
    s_nop 0
    buffer_load_dwordx4 v54, s[8:11], s41 offen sc1 lds
    s_lshl_b32 s41, s86, 19
    buffer_load_dwordx4 v[128:131], v1, s[4:7], s40 offen offset:0 sc1
    buffer_load_dwordx4 v[132:135], v1, s[4:7], s40 offen offset:1024 sc1
    buffer_load_dwordx4 v[136:139], v1, s[4:7], s40 offen offset:2048 sc1
    s_add_u32 s40, s40, 12288
    buffer_load_dwordx4 v[140:143], v1, s[4:7], s40 offen offset:0 sc1
    v_add_u32_e64 v78, s24, v9
    buffer_load_dwordx4 v[144:147], v1, s[4:7], s40 offen offset:1024 sc1
    ds_write_b128 v78, v[192:195] offset:0
    buffer_load_dwordx4 v[148:151], v1, s[4:7], s40 offen offset:2048 sc1
    ds_write_b128 v78, v[184:187] offset:4096
    s_add_u32 s40, s40, 12288
    ds_write_b128 v78, v[176:179] offset:8192
    buffer_load_dwordx4 v[152:155], v1, s[4:7], s40 offen offset:0 sc1
    ds_write_b128 v78, v[216:219] offset:12288
    buffer_load_dwordx4 v[156:159], v1, s[4:7], s40 offen offset:1024 sc1
    ds_write_b128 v78, v[208:211] offset:16384
    buffer_load_dwordx4 v[160:163], v1, s[4:7], s40 offen offset:2048 sc1
    ds_write_b128 v78, v[200:203] offset:20480
    s_add_u32 s40, s40, 12288
    buffer_load_dwordx4 v[68:71], v14, s[16:19], s45 offen sc1
    s_add_u32 s48, s48, 0x700000
    s_addc_u32 s49, s49, 0
    v_readfirstlane_b32 s38, v77
    s_lshl2_add_u32 s20, s3, s96
    s_add_u32 s20, s20, 32
    s_lshl3_add_u32 s96, s3, s96
    s_sub_u32 s96, s96, 1008
    s_cmp_eq_u32 s38, 0
    s_cselect_b32 s97, 393216, s96
    s_cselect_b32 s96, s96, 393216
    s_cselect_b32 s21, 393216, s20
    s_cselect_b32 s20, s20, 393216
    s_lshl_b32 s37, s2, 7
    s_lshl2_add_u32 s37, s3, s37
    s_add_u32 s73, s37, 32784
    s_lshl_b32 s37, s32, 11
    s_add_u32 s37, s37, 196608
    v_and_b32 v13, 0x3e0, v9
    v_add3_u32 v13, v13, v9, s37
    s_lshl2_add_u32 s39, s33, s3
    s_and_b32 s39, s39, 15
    s_cmp_ge_u32 s39, 14
    s_cselect_b32 s38, 14, 0
    s_sub_u32 s39, s39, s38
    s_lshl_b32 s39, s39, 10
    s_add_u32 s39, s39, L_tail-L_pc_b
    s_ashr_i32 s38, s39, 31
    s_getpc_b64 s[80:81]
L_pc_b:
    s_add_u32 s80, s80, s39
    s_addc_u32 s81, s81, s38
    s_nop 0
    ds_read_b128 v[80:83], v5 offset:24576
    ds_read_b128 v[88:91], v7 offset:24576
    ds_read_b128 v[84:87], v5 offset:25600
    ds_read_b128 v[92:95], v7 offset:25600
    ds_read_b128 v[96:99], v5 offset:26624
    ds_read_b128 v[104:107], v7 offset:26624
    ds_read_b128 v[100:103], v5 offset:27648
    ds_read_b128 v[108:111], v7 offset:27648
    s_waitcnt lgkmcnt(4)
    s_nop 0
    v_pk_fma_f16 v16, v88, s42, v80
    v_pk_fma_f16 v17, v89, s42, v81
    v_pk_fma_f16 v18, v90, s42, v82
    v_pk_fma_f16 v19, v91, s42, v83
    v_pk_fma_f16 v28, v92, s42, v84
    v_pk_fma_f16 v29, v93, s42, v85
    v_pk_fma_f16 v30, v94, s42, v86
    v_pk_fma_f16 v31, v95, s42, v87
    v_pk_add_f16 v20, v16, v28
    v_pk_add_f16 v21, v17, v29
    v_pk_add_f16 v22, v18, v30
    v_pk_add_f16 v23, v19, v31
    v_pk_add_f16 v24, v16, v28 neg_lo:[0,1] neg_hi:[0,1]
    v_pk_add_f16 v25, v17, v29 neg_lo:[0,1] neg_hi:[0,1]
    v_pk_add_f16 v26, v18, v30 neg_lo:[0,1] neg_hi:[0,1]
    v_pk_add_f16 v27, v19, v31 neg_lo:[0,1] neg_hi:[0,1]
    s_waitcnt lgkmcnt(0)
    s_nop 0
    v_pk_fma_f16 v32, v104, s42, v96
    v_pk_fma_f16 v33, v105, s42, v97
    v_pk_fma_f16 v34, v106, s42, v98
    v_pk_fma_f16 v35, v107, s42, v99
    v_pk_fma_f16 v44, v108, s42, v100
    v_pk_fma_f16 v45, v109, s42, v101
    v_pk_fma_f16 v46, v110, s42, v102
    v_pk_fma_f16 v47, v111, s42, v103
    v_pk_add_f16 v36, v32, v44
    v_pk_add_f16 v37, v33, v45
    v_pk_add_f16 v38, v34, v46
    v_pk_add_f16 v39, v35, v47
    v_pk_add_f16 v40, v32, v44 neg_lo:[0,1] neg_hi:[0,1]
    v_pk_add_f16 v41, v33, v45 neg_lo:[0,1] neg_hi:[0,1]
    v_pk_add_f16 v42, v34, v46 neg_lo:[0,1] neg_hi:[0,1]
    v_pk_add_f16 v43, v35, v47 neg_lo:[0,1] neg_hi:[0,1]
    s_waitcnt vmcnt(12)
    s_barrier
    ds_read_b128 v[80:83], v6 offset:24576
    ds_read_b128 v[88:91], v8 offset:24576
    ds_read_b128 v[84:87], v6 offset:25600
    ds_read_b128 v[92:95], v8 offset:25600
    ds_read_b128 v[96:99], v6 offset:26624
    ds_read_b128 v[104:107], v8 offset:26624
    ds_read_b128 v[100:103], v6 offset:27648
    ds_read_b128 v[108:111], v8 offset:27648
    buffer_load_dwordx4 v[164:167], v1, s[4:7], s40 offen offset:0 sc1
    buffer_load_dwordx4 v[168:171], v1, s[4:7], s40 offen offset:1024 sc1
    buffer_load_dwordx4 v[172:175], v1, s[4:7], s40 offen offset:2048 sc1
    s_add_u32 s40, s40, 12288
    buffer_load_dwordx4 v[176:179], v1, s[4:7], s40 offen offset:0 sc1
    buffer_load_dwordx4 v[180:183], v1, s[4:7], s40 offen offset:1024 sc1
    buffer_load_dwordx4 v[184:187], v1, s[4:7], s40 offen offset:2048 sc1
    s_add_u32 s40, s40, 12288
    s_waitcnt vmcnt(10)
    s_nop 0
    v_pk_add_f16 v112, v132, v136
    v_pk_add_f16 v113, v133, v137
    v_pk_add_f16 v114, v134, v138
    v_pk_add_f16 v115, v135, v139
    v_pk_add_f16 v136, v128, v136
    v_pk_add_f16 v137, v129, v137
    v_pk_add_f16 v138, v130, v138
    v_pk_add_f16 v139, v131, v139
    v_pk_add_f16 v116, v144, v148
    v_pk_add_f16 v117, v145, v149
    v_pk_add_f16 v118, v146, v150
    buffer_load_dwordx4 v[188:191], v1, s[4:7], s40 offen offset:0 sc1
    buffer_load_dwordx4 v[192:195], v1, s[4:7], s40 offen offset:1024 sc1
    buffer_load_dwordx4 v[196:199], v1, s[4:7], s40 offen offset:2048 sc1
    s_mov_b32 s47, 2
    s_mov_b32 s72, s45
    s_waitcnt vmcnt(9)
    v_cmp_gt_i32 vcc, 0, v69
    v_cmp_gt_u32 s[38:39], 2, v70
    s_xor_b64 vcc, vcc, s[76:77]
    s_and_b64 s[38:39], s[38:39], s[0:1]
    s_or_b64 vcc, vcc, s[38:39]
    s_and_b64 vcc, vcc, s[22:23]
    s_cbranch_scc1 L_polla0_slow
L_polla0_out:
    s_branch L_loop
L_pstat0_slow:
    s_mov_b32 s37, 262144
    s_mov_b64 exec, s[20:21]
L_pstat0:
    buffer_load_dwordx4 v[72:75], v13, s[16:19], s45 offen sc1
    s_sub_u32 s37, s37, 1
    s_cbranch_scc1 L_pstat0_end
    s_waitcnt vmcnt(0)
    v_cmp_gt_i32 vcc, 0, v73
    s_nop 0
    s_xor_b64 vcc, vcc, s[72:73]
    s_and_b64 vcc, vcc, s[20:21]
    s_cbranch_scc1 L_pstat0
L_pstat0_end:
    s_mov_b64 exec, -1
    s_branch L_pstat0_out
    s_nop 0
L_masks_slow:
    s_mov_b32 s37, 262144
L_masks:
    global_load_dwordx4 v[112:115], v120, s[92:93] sc1
    global_load_dwordx4 v[116:119], v121, s[92:93] sc1
    s_sub_u32 s37, s37, 1
    s_cbranch_scc1 L_masks_out
    s_waitcnt vmcnt(0)
    v_and_b32 v114, v114, v118
    v_cmp_ne_u32 vcc, 1, v114
    s_nop 0
    s_cmp_lg_u64 vcc, 0
    s_cbranch_scc1 L_masks
    s_branch L_masks_out
    s_nop 0
L_polle0_slow:
    s_mov_b32 s37, 262144
    s_mov_b64 exec, s[22:23]
L_polle0:
    buffer_load_dwordx4 v[72:75], v11, s[16:19], s45 offen sc1
    s_sub_u32 s37, s37, 1
    s_cbranch_scc1 L_polle0_end
    s_waitcnt vmcnt(0)
    v_cmp_gt_i32_e64 vcc, 0, v73
    v_cmp_gt_u32 s[38:39], 1, v74
    s_xor_b64 vcc, vcc, s[74:75]
    s_or_b64 vcc, vcc, s[38:39]
    s_and_b64 vcc, vcc, s[22:23]
    s_cbranch_scc1 L_polle0
L_polle0_end:
    s_mov_b64 exec, -1
    s_branch L_polle0_out
L_polla0_slow:
    s_mov_b32 s37, 262144
    s_mov_b64 exec, s[22:23]
L_polla0:
    buffer_load_dwordx4 v[68:71], v14, s[16:19], s45 offen sc1
    s_sub_u32 s37, s37, 1
    s_cbranch_scc1 L_polla0_end
    s_waitcnt vmcnt(0)
    v_cmp_gt_i32_e64 vcc, 0, v69
    v_cmp_gt_u32 s[38:39], 2, v70
    s_xor_b64 vcc, vcc, s[76:77]
    s_and_b64 s[38:39], s[38:39], s[0:1]
    s_or_b64 vcc, vcc, s[38:39]
    s_and_b64 vcc, vcc, s[22:23]
    s_cbranch_scc1 L_polla0
L_polla0_end:
    s_mov_b64 exec, -1
    s_branch L_polla0_out
L_padC:
    s_branch L_back
L_brk:
    s_bitcmp1_b32 s84, 0
    s_cbranch_scc1 L_brk_b
    s_add_u32 s84, s84, 1
    s_mov_b32 s44, 4
    s_mov_b32 s37, 262144
    s_mov_b32 s72, 393216
    s_waitcnt vmcnt(10)
    v_cmp_gt_u32 vcc, s47, v0
    s_nop 0
    s_and_b64 vcc, vcc, s[22:23]
    s_cbranch_scc0 L_loop
L_all:
    buffer_load_dword v0, v14, s[16:19], s45 offen offset:8 sc1
    s_sub_u32 s37, s37, 1
    s_cbranch_scc1 L_loop
    s_waitcnt vmcnt(0)
    v_cmp_gt_u32 vcc, s47, v0
    s_nop 0
    s_and_b64 vcc, vcc, s[22:23]
    s_cbranch_scc1 L_all
    s_branch L_loop
L_brk_b:
    v_add_co_u32 v204, vcc, s80, v9
    v_mov_b32 v205, s81
    s_add_u32 s84, s84, 1
    s_mov_b32 s44, 0
    v_addc_co_u32 v205, vcc, 0, v205, vcc
    global_load_dword v200, v[204:205], off
    s_branch L_loop
.p2alignl 12, 0xbf810000
L_padA:
    s_branch L_back
    s_nop 0
L_loop:
    v_mfma_f32_16x16x32_f16 a[0:3], v[128:131], v[16:19], a[0:3]
    s_add_u32 s40, s40, 12288
    v_pk_add_f16 v119, v147, v151
    v_pk_add_f16 v148, v140, v148
    v_mfma_f32_16x16x32_f16 a[32:35], v[140:143], v[16:19], a[32:35]
    buffer_load_dwordx4 v[200:203], v1, s[4:7], s40 offen offset:0 sc1
    v_pk_add_f16 v149, v141, v149
    v_mfma_f32_16x16x32_f16 a[8:11], v[132:135], v[20:23], a[8:11]
    v_pk_add_f16 v150, v142, v150
    v_pk_add_f16 v151, v143, v151
    v_mfma_f32_16x16x32_f16 a[40:43], v[144:147], v[20:23], a[40:43]
    s_waitcnt lgkmcnt(4)
    v_pk_fma_f16 v48, v88, s42, v80
    v_pk_fma_f16 v49, v89, s42, v81
    v_mfma_f32_16x16x32_f16 a[24:27], v[112:115], v[28:31], a[24:27]
    buffer_load_dwordx4 v[204:207], v1, s[4:7], s40 offen offset:1024 sc1
    v_pk_fma_f16 v50, v90, s42, v82
    v_mfma_f32_16x16x32_f16 a[56:59], v[116:119], v[28:31], a[56:59]
    v_pk_fma_f16 v51, v91, s42, v83
    v_pk_fma_f16 v60, v92, s42, v84
    v_mfma_f32_16x16x32_f16 a[16:19], v[136:139], v[24:27], a[16:19]
    s_add_u32 m0, s43, 24576
    v_pk_fma_f16 v61, v93, s42, v85
    v_pk_fma_f16 v62, v94, s42, v86
    v_mfma_f32_16x16x32_f16 a[48:51], v[148:151], v[24:27], a[48:51]
    s_waitcnt vmcnt(11) lgkmcnt(0)
    v_pk_fma_f16 v63, v95, s42, v87
    v_pk_add_f16 v52, v48, v60
    v_mfma_f32_16x16x32_f16 a[4:7], v[128:131], v[32:35], a[4:7]
    buffer_load_dwordx4 v[208:211], v1, s[4:7], s40 offen offset:2048 sc1
    v_pk_add_f16 v53, v49, v61
    v_mfma_f32_16x16x32_f16 a[36:39], v[140:143], v[32:35], a[36:39]
    s_barrier
    v_pk_add_f16 v54, v50, v62
    v_pk_add_f16 v55, v51, v63
    v_mfma_f32_16x16x32_f16 a[28:31], v[112:115], v[44:47], a[28:31]
    ds_read_b128 v[80:83], v5 offset:0
    v_pk_add_f16 v56, v48, v60 neg_lo:[0,1] neg_hi:[0,1]
    v_mfma_f32_16x16x32_f16 a[60:63], v[116:119], v[44:47], a[60:63]
    buffer_load_dwordx4 v2, s[8:11], s41 offen offset:0 sc1 lds
    v_pk_add_f16 v57, v49, v61 neg_lo:[0,1] neg_hi:[0,1]
    v_mfma_f32_16x16x32_f16 a[12:15], v[132:135], v[36:39], a[12:15]
    s_add_u32 s40, s40, 12288
    v_pk_add_f16 v58, v50, v62 neg_lo:[0,1] neg_hi:[0,1]
    v_pk_add_f16 v59, v51, v63 neg_lo:[0,1] neg_hi:[0,1]
    v_mfma_f32_16x16x32_f16 a[44:47], v[144:147], v[36:39], a[44:47]
    ds_read_b128 v[88:91], v7 offset:0
    v_pk_fma_f16 v64, v104, s42, v96
    v_mfma_f32_16x16x32_f16 a[20:23], v[136:139], v[40:43], a[20:23]
    v_pk_fma_f16 v65, v105, s42, v97
    v_pk_fma_f16 v66, v106, s42, v98
    v_mfma_f32_16x16x32_f16 a[52:55], v[148:151], v[40:43], a[52:55]
    buffer_load_dwordx4 v2, s[8:11], s41 offen offset:1024 sc1 lds
    v_pk_fma_f16 v67, v107, s42, v99
    v_mfma_f32_16x16x32_f16 a[64:67], v[128:131], v[48:51], a[64:67]
    ds_read_b128 v[84:87], v5 offset:1024
    v_pk_fma_f16 v76, v108, s42, v100
    v_mfma_f32_16x16x32_f16 a[96:99], v[140:143], v[48:51], a[96:99]
    v_pk_fma_f16 v77, v109, s42, v101
    v_pk_fma_f16 v78, v110, s42, v102
    v_mfma_f32_16x16x32_f16 a[88:91], v[112:115], v[60:63], a[88:91]
    buffer_load_dwordx4 v3, s[8:11], s41 offen offset:2048 sc1 lds
    v_pk_fma_f16 v79, v111, s42, v103
    v_mfma_f32_16x16x32_f16 a[120:123], v[116:119], v[60:63], a[120:123]
    ds_read_b128 v[92:95], v7 offset:1024
    v_pk_add_f16 v68, v64, v76
    v_mfma_f32_16x16x32_f16 a[72:75], v[132:135], v[52:55], a[72:75]
    v_pk_add_f16 v69, v65, v77
    v_pk_add_f16 v70, v66, v78
    v_mfma_f32_16x16x32_f16 a[104:107], v[144:147], v[52:55], a[104:107]
    buffer_load_dwordx4 v3, s[8:11], s41 offen offset:3072 sc1 lds
    v_pk_add_f16 v71, v67, v79
    v_mfma_f32_16x16x32_f16 a[80:83], v[136:139], v[56:59], a[80:83]
    ds_read_b128 v[96:99], v5 offset:2048
    v_pk_add_f16 v72, v64, v76 neg_lo:[0,1] neg_hi:[0,1]
    v_mfma_f32_16x16x32_f16 a[112:115], v[148:151], v[56:59], a[112:115]
    s_add_u32 m0, s43, 28672
    v_pk_add_f16 v73, v65, v77 neg_lo:[0,1] neg_hi:[0,1]
    v_pk_add_f16 v74, v66, v78 neg_lo:[0,1] neg_hi:[0,1]
    v_mfma_f32_16x16x32_f16 a[68:71], v[128:131], v[64:67], a[68:71]
    s_waitcnt vmcnt(23)
    v_pk_add_f16 v75, v67, v79 neg_lo:[0,1] neg_hi:[0,1]
    v_pk_add_f16 v120, v156, v160
    v_mfma_f32_16x16x32_f16 a[100:103], v[140:143], v[64:67], a[100:103]
    ds_read_b128 v[104:107], v7 offset:2048
    v_pk_add_f16 v121, v157, v161
    v_mfma_f32_16x16x32_f16 a[92:95], v[112:115], v[76:79], a[92:95]
    buffer_load_dwordx4 v4, s[8:11], s41 offen offset:0 sc1 lds
    v_pk_add_f16 v122, v158, v162
    v_mfma_f32_16x16x32_f16 a[124:127], v[116:119], v[76:79], a[124:127]
    v_pk_add_f16 v123, v159, v163
    v_pk_add_f16 v160, v152, v160
    v_mfma_f32_16x16x32_f16 a[76:79], v[132:135], v[68:71], a[76:79]
    ds_read_b128 v[100:103], v5 offset:3072
    v_pk_add_f16 v161, v153, v161
    v_mfma_f32_16x16x32_f16 a[108:111], v[144:147], v[68:71], a[108:111]
    buffer_load_dwordx4 v4, s[8:11], s41 offen offset:1024 sc1 lds
    v_pk_add_f16 v162, v154, v162
    v_mfma_f32_16x16x32_f16 a[84:87], v[136:139], v[72:75], a[84:87]
    s_waitcnt vmcnt(15)
    v_pk_add_f16 v163, v155, v163
    v_pk_add_f16 v124, v168, v172
    v_pk_add_f16 v125, v169, v173
    v_mfma_f32_16x16x32_f16 a[116:119], v[148:151], v[72:75], a[116:119]
    ds_read_b128 v[108:111], v7 offset:3072
    v_pk_add_f16 v126, v170, v174
    v_mfma_f32_16x16x32_f16 a[128:131], v[152:155], v[16:19], a[128:131]
    s_add_u32 s41, s41, 0x40000
    v_pk_add_f16 v127, v171, v175
    v_pk_add_f16 v172, v164, v172
    v_mfma_f32_16x16x32_f16 a[160:163], v[164:167], v[16:19], a[160:163]
    buffer_load_dwordx4 v[212:215], v1, s[4:7], s40 offen offset:0 sc1
    v_pk_add_f16 v173, v165, v173
    v_mfma_f32_16x16x32_f16 a[136:139], v[156:159], v[20:23], a[136:139]
    v_pk_add_f16 v174, v166, v174
    v_pk_add_f16 v175, v167, v175
    v_mfma_f32_16x16x32_f16 a[168:171], v[168:171], v[20:23], a[168:171]
    s_waitcnt lgkmcnt(4)
    v_pk_fma_f16 v16, v88, s42, v80
    v_pk_fma_f16 v17, v89, s42, v81
    v_mfma_f32_16x16x32_f16 a[152:155], v[120:123], v[28:31], a[152:155]
    buffer_load_dwordx4 v[216:219], v1, s[4:7], s40 offen offset:1024 sc1
    v_pk_fma_f16 v18, v90, s42, v82
    v_mfma_f32_16x16x32_f16 a[184:187], v[124:127], v[28:31], a[184:187]
    v_pk_fma_f16 v19, v91, s42, v83
    v_pk_fma_f16 v28, v92, s42, v84
    v_mfma_f32_16x16x32_f16 a[144:147], v[160:163], v[24:27], a[144:147]
    v_pk_fma_f16 v29, v93, s42, v85
    v_pk_fma_f16 v30, v94, s42, v86
    v_mfma_f32_16x16x32_f16 a[176:179], v[172:175], v[24:27], a[176:179]
    v_pk_fma_f16 v31, v95, s42, v87
    v_pk_add_f16 v20, v16, v28
    v_mfma_f32_16x16x32_f16 a[132:135], v[152:155], v[32:35], a[132:135]
    buffer_load_dwordx4 v[220:223], v1, s[4:7], s40 offen offset:2048 sc1
    v_pk_add_f16 v21, v17, v29
    v_mfma_f32_16x16x32_f16 a[164:167], v[164:167], v[32:35], a[164:167]
    s_mul_i32 s40, s86, 98304
    v_pk_add_f16 v22, v18, v30
    v_pk_add_f16 v23, v19, v31
    v_mfma_f32_16x16x32_f16 a[156:159], v[120:123], v[44:47], a[156:159]
    ds_read_b128 v[80:83], v6 offset:0
    v_pk_add_f16 v24, v16, v28 neg_lo:[0,1] neg_hi:[0,1]
    v_mfma_f32_16x16x32_f16 a[188:191], v[124:127], v[44:47], a[188:191]
    buffer_load_dwordx4 v[128:131], v1, s[4:7], s40 offen offset:0 sc1
    v_pk_add_f16 v25, v17, v29 neg_lo:[0,1] neg_hi:[0,1]
    v_mfma_f32_16x16x32_f16 a[140:143], v[156:159], v[36:39], a[140:143]
    s_waitcnt lgkmcnt(1)
    v_pk_add_f16 v26, v18, v30 neg_lo:[0,1] neg_hi:[0,1]
    v_pk_add_f16 v27, v19, v31 neg_lo:[0,1] neg_hi:[0,1]
    v_mfma_f32_16x16x32_f16 a[172:175], v[168:171], v[36:39], a[172:175]
    ds_read_b128 v[88:91], v8 offset:0
    v_pk_fma_f16 v32, v104, s42, v96
    v_mfma_f32_16x16x32_f16 a[148:151], v[160:163], v[40:43], a[148:151]
    v_pk_fma_f16 v33, v105, s42, v97
    v_pk_fma_f16 v34, v106, s42, v98
    v_mfma_f32_16x16x32_f16 a[180:183], v[172:175], v[40:43], a[180:183]
    buffer_load_dwordx4 v[132:135], v1, s[4:7], s40 offen offset:1024 sc1
    v_pk_fma_f16 v35, v107, s42, v99
    v_mfma_f32_16x16x32_f16 a[192:195], v[152:155], v[48:51], a[192:195]
    ds_read_b128 v[84:87], v6 offset:1024
    v_pk_fma_f16 v44, v108, s42, v100
    v_mfma_f32_16x16x32_f16 a[224:227], v[164:167], v[48:51], a[224:227]
    v_pk_fma_f16 v45, v109, s42, v101
    v_pk_fma_f16 v46, v110, s42, v102
    v_mfma_f32_16x16x32_f16 a[216:219], v[120:123], v[60:63], a[216:219]
    buffer_load_dwordx4 v[136:139], v1, s[4:7], s40 offen offset:2048 sc1
    v_pk_fma_f16 v47, v111, s42, v103
    v_mfma_f32_16x16x32_f16 a[248:251], v[124:127], v[60:63], a[248:251]
    ds_read_b128 v[92:95], v8 offset:1024
    v_pk_add_f16 v36, v32, v44
    v_mfma_f32_16x16x32_f16 a[200:203], v[156:159], v[52:55], a[200:203]
    s_add_u32 s40, s40, 12288
    v_pk_add_f16 v37, v33, v45
    v_pk_add_f16 v38, v34, v46
    v_mfma_f32_16x16x32_f16 a[232:235], v[168:171], v[52:55], a[232:235]
    buffer_load_dwordx4 v[140:143], v1, s[4:7], s40 offen offset:0 sc1
    v_pk_add_f16 v39, v35, v47
    v_mfma_f32_16x16x32_f16 a[208:211], v[160:163], v[56:59], a[208:211]
    ds_read_b128 v[96:99], v6 offset:2048
    v_pk_add_f16 v40, v32, v44 neg_lo:[0,1] neg_hi:[0,1]
    v_mfma_f32_16x16x32_f16 a[240:243], v[172:175], v[56:59], a[240:243]
    v_pk_add_f16 v41, v33, v45 neg_lo:[0,1] neg_hi:[0,1]
    v_pk_add_f16 v42, v34, v46 neg_lo:[0,1] neg_hi:[0,1]
    v_mfma_f32_16x16x32_f16 a[196:199], v[152:155], v[64:67], a[196:199]
    s_waitcnt vmcnt(19)
    v_pk_add_f16 v43, v35, v47 neg_lo:[0,1] neg_hi:[0,1]
    v_pk_add_f16 v112, v180, v184
    v_mfma_f32_16x16x32_f16 a[228:231], v[164:167], v[64:67], a[228:231]
    ds_read_b128 v[104:107], v8 offset:2048
    v_pk_add_f16 v113, v181, v185
    v_mfma_f32_16x16x32_f16 a[220:223], v[120:123], v[76:79], a[220:223]
    buffer_load_dwordx4 v[144:147], v1, s[4:7], s40 offen offset:1024 sc1
    v_pk_add_f16 v114, v182, v186
    v_mfma_f32_16x16x32_f16 a[252:255], v[124:127], v[76:79], a[252:255]
    v_pk_add_f16 v115, v183, v187
    v_pk_add_f16 v184, v176, v184
    v_mfma_f32_16x16x32_f16 a[204:207], v[156:159], v[68:71], a[204:207]
    ds_read_b128 v[100:103], v6 offset:3072
    v_pk_add_f16 v185, v177, v185
    v_mfma_f32_16x16x32_f16 a[236:239], v[168:171], v[68:71], a[236:239]
    buffer_load_dwordx4 v[148:151], v1, s[4:7], s40 offen offset:2048 sc1
    v_pk_add_f16 v186, v178, v186
    v_mfma_f32_16x16x32_f16 a[212:215], v[160:163], v[72:75], a[212:215]
    s_waitcnt vmcnt(18)
    v_pk_add_f16 v187, v179, v187
    v_pk_add_f16 v116, v192, v196
    v_pk_add_f16 v117, v193, v197
    v_mfma_f32_16x16x32_f16 a[244:247], v[172:175], v[72:75], a[244:247]
    ds_read_b128 v[108:111], v8 offset:3072
    v_pk_add_f16 v118, v194, v198
    v_mfma_f32_16x16x32_f16 a[0:3], v[176:179], v[16:19], a[0:3]
    s_add_u32 s40, s40, 12288
    v_pk_add_f16 v119, v195, v199
    v_pk_add_f16 v196, v188, v196
    v_mfma_f32_16x16x32_f16 a[32:35], v[188:191], v[16:19], a[32:35]
    buffer_load_dwordx4 v[152:155], v1, s[4:7], s40 offen offset:0 sc1
    v_pk_add_f16 v197, v189, v197
    v_mfma_f32_16x16x32_f16 a[8:11], v[180:183], v[20:23], a[8:11]
    v_pk_add_f16 v198, v190, v198
    v_pk_add_f16 v199, v191, v199
    v_mfma_f32_16x16x32_f16 a[40:43], v[192:195], v[20:23], a[40:43]
    s_waitcnt lgkmcnt(4)
    v_pk_fma_f16 v48, v88, s42, v80
    v_pk_fma_f16 v49, v89, s42, v81
    v_mfma_f32_16x16x32_f16 a[24:27], v[112:115], v[28:31], a[24:27]
    buffer_load_dwordx4 v[156:159], v1, s[4:7], s40 offen offset:1024 sc1
    v_pk_fma_f16 v50, v90, s42, v82
    v_mfma_f32_16x16x32_f16 a[56:59], v[116:119], v[28:31], a[56:59]
    v_pk_fma_f16 v51, v91, s42, v83
    v_pk_fma_f16 v60, v92, s42, v84
    v_mfma_f32_16x16x32_f16 a[16:19], v[184:187], v[24:27], a[16:19]
    s_add_u32 m0, s43, 0
    v_pk_fma_f16 v61, v93, s42, v85
    v_pk_fma_f16 v62, v94, s42, v86
    v_mfma_f32_16x16x32_f16 a[48:51], v[196:199], v[24:27], a[48:51]
    s_waitcnt vmcnt(11) lgkmcnt(0)
    v_pk_fma_f16 v63, v95, s42, v87
    v_pk_add_f16 v52, v48, v60
    v_mfma_f32_16x16x32_f16 a[4:7], v[176:179], v[32:35], a[4:7]
    buffer_load_dwordx4 v[160:163], v1, s[4:7], s40 offen offset:2048 sc1
    v_pk_add_f16 v53, v49, v61
    v_mfma_f32_16x16x32_f16 a[36:39], v[188:191], v[32:35], a[36:39]
    s_barrier
    v_pk_add_f16 v54, v50, v62
    v_pk_add_f16 v55, v51, v63
    v_mfma_f32_16x16x32_f16 a[28:31], v[112:115], v[44:47], a[28:31]
    ds_read_b128 v[80:83], v5 offset:24576
    v_pk_add_f16 v56, v48, v60 neg_lo:[0,1] neg_hi:[0,1]
    v_mfma_f32_16x16x32_f16 a[60:63], v[116:119], v[44:47], a[60:63]
    buffer_load_dwordx4 v2, s[8:11], s41 offen offset:0 sc1 lds
    v_pk_add_f16 v57, v49, v61 neg_lo:[0,1] neg_hi:[0,1]
    v_mfma_f32_16x16x32_f16 a[12:15], v[180:183], v[36:39], a[12:15]
    s_add_u32 s40, s40, 12288
    v_pk_add_f16 v58, v50, v62 neg_lo:[0,1] neg_hi:[0,1]
    v_pk_add_f16 v59, v51, v63 neg_lo:[0,1] neg_hi:[0,1]
    v_mfma_f32_16x16x32_f16 a[44:47], v[192:195], v[36:39], a[44:47]
    ds_read_b128 v[88:91], v7 offset:24576
    v_pk_fma_f16 v64, v104, s42, v96
    v_mfma_f32_16x16x32_f16 a[20:23], v[184:187], v[40:43], a[20:23]
    s_ashr_i32 s85, s85, 4
    v_pk_fma_f16 v65, v105, s42, v97
    v_pk_fma_f16 v66, v106, s42, v98
    v_mfma_f32_16x16x32_f16 a[52:55], v[196:199], v[40:43], a[52:55]
    buffer_load_dwordx4 v2, s[8:11], s41 offen offset:1024 sc1 lds
    v_pk_fma_f16 v67, v107, s42, v99
    v_mfma_f32_16x16x32_f16 a[64:67], v[176:179], v[48:51], a[64:67]
    ds_read_b128 v[84:87], v5 offset:25600
    v_pk_fma_f16 v76, v108, s42, v100
    v_mfma_f32_16x16x32_f16 a[96:99], v[188:191], v[48:51], a[96:99]
    s_and_b32 s86, s85, 15
    v_pk_fma_f16 v77, v109, s42, v101
    v_pk_fma_f16 v78, v110, s42, v102
    v_mfma_f32_16x16x32_f16 a[88:91], v[112:115], v[60:63], a[88:91]
    buffer_load_dwordx4 v3, s[8:11], s41 offen offset:2048 sc1 lds
    v_pk_fma_f16 v79, v111, s42, v103
    v_mfma_f32_16x16x32_f16 a[120:123], v[116:119], v[60:63], a[120:123]
    ds_read_b128 v[92:95], v7 offset:25600
    v_pk_add_f16 v68, v64, v76
    v_mfma_f32_16x16x32_f16 a[72:75], v[180:183], v[52:55], a[72:75]
    v_pk_add_f16 v69, v65, v77
    v_pk_add_f16 v70, v66, v78
    v_mfma_f32_16x16x32_f16 a[104:107], v[192:195], v[52:55], a[104:107]
    buffer_load_dwordx4 v3, s[8:11], s41 offen offset:3072 sc1 lds
    v_pk_add_f16 v71, v67, v79
    v_mfma_f32_16x16x32_f16 a[80:83], v[184:187], v[56:59], a[80:83]
    ds_read_b128 v[96:99], v5 offset:26624
    v_pk_add_f16 v72, v64, v76 neg_lo:[0,1] neg_hi:[0,1]
    v_mfma_f32_16x16x32_f16 a[112:115], v[196:199], v[56:59], a[112:115]
    s_add_u32 m0, s43, 4096
    v_pk_add_f16 v73, v65, v77 neg_lo:[0,1] neg_hi:[0,1]
    v_pk_add_f16 v74, v66, v78 neg_lo:[0,1] neg_hi:[0,1]
    v_mfma_f32_16x16x32_f16 a[68:71], v[176:179], v[64:67], a[68:71]
    s_waitcnt vmcnt(22)
    v_pk_add_f16 v75, v67, v79 neg_lo:[0,1] neg_hi:[0,1]
    v_pk_add_f16 v120, v204, v208
    v_mfma_f32_16x16x32_f16 a[100:103], v[188:191], v[64:67], a[100:103]
    ds_read_b128 v[104:107], v7 offset:26624
    v_pk_add_f16 v121, v205, v209
    v_mfma_f32_16x16x32_f16 a[92:95], v[112:115], v[76:79], a[92:95]
    buffer_load_dwordx4 v4, s[8:11], s41 offen offset:0 sc1 lds
    v_pk_add_f16 v122, v206, v210
    v_mfma_f32_16x16x32_f16 a[124:127], v[116:119], v[76:79], a[124:127]
    buffer_load_dword v0, v14, s[16:19], s72 offen offset:8 sc1
    v_pk_add_f16 v123, v207, v211
    v_pk_add_f16 v208, v200, v208
    v_mfma_f32_16x16x32_f16 a[76:79], v[180:183], v[68:71], a[76:79]
    ds_read_b128 v[100:103], v5 offset:27648
    v_pk_add_f16 v209, v201, v209
    v_mfma_f32_16x16x32_f16 a[108:111], v[192:195], v[68:71], a[108:111]
    buffer_load_dwordx4 v4, s[8:11], s41 offen offset:1024 sc1 lds
    v_pk_add_f16 v210, v202, v210
    v_mfma_f32_16x16x32_f16 a[84:87], v[184:187], v[72:75], a[84:87]
    s_waitcnt vmcnt(16)
    v_pk_add_f16 v211, v203, v211
    v_pk_add_f16 v124, v216, v220
    v_pk_add_f16 v125, v217, v221
    v_mfma_f32_16x16x32_f16 a[116:119], v[196:199], v[72:75], a[116:119]
    ds_read_b128 v[108:111], v7 offset:27648
    v_pk_add_f16 v126, v218, v222
    v_mfma_f32_16x16x32_f16 a[128:131], v[200:203], v[16:19], a[128:131]
    s_lshl_b32 s41, s86, 19
    v_pk_add_f16 v127, v219, v223
    v_pk_add_f16 v220, v212, v220
    v_mfma_f32_16x16x32_f16 a[160:163], v[212:215], v[16:19], a[160:163]
    buffer_load_dwordx4 v[164:167], v1, s[4:7], s40 offen offset:0 sc1
    v_pk_add_f16 v221, v213, v221
    v_mfma_f32_16x16x32_f16 a[136:139], v[204:207], v[20:23], a[136:139]
    v_pk_add_f16 v222, v214, v222
    v_pk_add_f16 v223, v215, v223
    v_mfma_f32_16x16x32_f16 a[168:171], v[216:219], v[20:23], a[168:171]
    s_waitcnt lgkmcnt(4)
    v_pk_fma_f16 v16, v88, s42, v80
    v_pk_fma_f16 v17, v89, s42, v81
    v_mfma_f32_16x16x32_f16 a[152:155], v[120:123], v[28:31], a[152:155]
    buffer_load_dwordx4 v[168:171], v1, s[4:7], s40 offen offset:1024 sc1
    v_pk_fma_f16 v18, v90, s42, v82
    v_mfma_f32_16x16x32_f16 a[184:187], v[124:127], v[28:31], a[184:187]
    v_pk_fma_f16 v19, v91, s42, v83
    v_pk_fma_f16 v28, v92, s42, v84
    v_mfma_f32_16x16x32_f16 a[144:147], v[208:211], v[24:27], a[144:147]
    v_pk_fma_f16 v29, v93, s42, v85
    v_pk_fma_f16 v30, v94, s42, v86
    v_mfma_f32_16x16x32_f16 a[176:179], v[220:223], v[24:27], a[176:179]
    v_pk_fma_f16 v31, v95, s42, v87
    v_pk_add_f16 v20, v16, v28
    v_mfma_f32_16x16x32_f16 a[132:135], v[200:203], v[32:35], a[132:135]
    buffer_load_dwordx4 v[172:175], v1, s[4:7], s40 offen offset:2048 sc1
    v_pk_add_f16 v21, v17, v29
    v_mfma_f32_16x16x32_f16 a[164:167], v[212:215], v[32:35], a[164:167]
    s_add_u32 s40, s40, 12288
    v_pk_add_f16 v22, v18, v30
    v_pk_add_f16 v23, v19, v31
    v_mfma_f32_16x16x32_f16 a[156:159], v[120:123], v[44:47], a[156:159]
    ds_read_b128 v[80:83], v6 offset:24576
    v_pk_add_f16 v24, v16, v28 neg_lo:[0,1] neg_hi:[0,1]
    v_mfma_f32_16x16x32_f16 a[188:191], v[124:127], v[44:47], a[188:191]
    buffer_load_dwordx4 v[176:179], v1, s[4:7], s40 offen offset:0 sc1
    v_pk_add_f16 v25, v17, v29 neg_lo:[0,1] neg_hi:[0,1]
    v_mfma_f32_16x16x32_f16 a[140:143], v[204:207], v[36:39], a[140:143]
    s_waitcnt lgkmcnt(1)
    v_pk_add_f16 v26, v18, v30 neg_lo:[0,1] neg_hi:[0,1]
    v_pk_add_f16 v27, v19, v31 neg_lo:[0,1] neg_hi:[0,1]
    v_mfma_f32_16x16x32_f16 a[172:175], v[216:219], v[36:39], a[172:175]
    ds_read_b128 v[88:91], v8 offset:24576
    v_pk_fma_f16 v32, v104, s42, v96
    v_mfma_f32_16x16x32_f16 a[148:151], v[208:211], v[40:43], a[148:151]
    v_pk_fma_f16 v33, v105, s42, v97
    v_pk_fma_f16 v34, v106, s42, v98
    v_mfma_f32_16x16x32_f16 a[180:183], v[220:223], v[40:43], a[180:183]
    buffer_load_dwordx4 v[180:183], v1, s[4:7], s40 offen offset:1024 sc1
    v_pk_fma_f16 v35, v107, s42, v99
    v_mfma_f32_16x16x32_f16 a[192:195], v[200:203], v[48:51], a[192:195]
    ds_read_b128 v[84:87], v6 offset:25600
    v_pk_fma_f16 v44, v108, s42, v100
    v_mfma_f32_16x16x32_f16 a[224:227], v[212:215], v[48:51], a[224:227]
    v_pk_fma_f16 v45, v109, s42, v101
    v_pk_fma_f16 v46, v110, s42, v102
    v_mfma_f32_16x16x32_f16 a[216:219], v[120:123], v[60:63], a[216:219]
    buffer_load_dwordx4 v[184:187], v1, s[4:7], s40 offen offset:2048 sc1
    v_pk_fma_f16 v47, v111, s42, v103
    v_mfma_f32_16x16x32_f16 a[248:251], v[124:127], v[60:63], a[248:251]
    ds_read_b128 v[92:95], v8 offset:25600
    v_pk_add_f16 v36, v32, v44
    v_mfma_f32_16x16x32_f16 a[200:203], v[204:207], v[52:55], a[200:203]
    s_add_u32 s40, s40, 12288
    v_pk_add_f16 v37, v33, v45
    v_pk_add_f16 v38, v34, v46
    v_mfma_f32_16x16x32_f16 a[232:235], v[216:219], v[52:55], a[232:235]
    buffer_load_dwordx4 v[188:191], v1, s[4:7], s40 offen offset:0 sc1
    v_pk_add_f16 v39, v35, v47
    v_mfma_f32_16x16x32_f16 a[208:211], v[208:211], v[56:59], a[208:211]
    ds_read_b128 v[96:99], v6 offset:26624
    v_pk_add_f16 v40, v32, v44 neg_lo:[0,1] neg_hi:[0,1]
    v_mfma_f32_16x16x32_f16 a[240:243], v[220:223], v[56:59], a[240:243]
    s_sub_u32 s44, s44, 1
    v_pk_add_f16 v41, v33, v45 neg_lo:[0,1] neg_hi:[0,1]
    v_pk_add_f16 v42, v34, v46 neg_lo:[0,1] neg_hi:[0,1]
    v_mfma_f32_16x16x32_f16 a[196:199], v[200:203], v[64:67], a[196:199]
    s_waitcnt vmcnt(20)
    v_pk_add_f16 v43, v35, v47 neg_lo:[0,1] neg_hi:[0,1]
    v_pk_add_f16 v112, v132, v136
    v_mfma_f32_16x16x32_f16 a[228:231], v[212:215], v[64:67], a[228:231]
    ds_read_b128 v[104:107], v8 offset:26624
    v_pk_add_f16 v113, v133, v137
    v_mfma_f32_16x16x32_f16 a[220:223], v[120:123], v[76:79], a[220:223]
    buffer_load_dwordx4 v[192:195], v1, s[4:7], s40 offen offset:1024 sc1
    v_pk_add_f16 v114, v134, v138
    v_mfma_f32_16x16x32_f16 a[252:255], v[124:127], v[76:79], a[252:255]
    v_pk_add_f16 v115, v135, v139
    v_pk_add_f16 v136, v128, v136
    v_mfma_f32_16x16x32_f16 a[204:207], v[204:207], v[68:71], a[204:207]
    ds_read_b128 v[100:103], v6 offset:27648
    v_pk_add_f16 v137, v129, v137
    v_mfma_f32_16x16x32_f16 a[236:239], v[216:219], v[68:71], a[236:239]
    buffer_load_dwordx4 v[196:199], v1, s[4:7], s40 offen offset:2048 sc1
    v_pk_add_f16 v138, v130, v138
    v_mfma_f32_16x16x32_f16 a[212:215], v[208:211], v[72:75], a[212:215]
    s_waitcnt vmcnt(19)
    v_pk_add_f16 v139, v131, v139
    v_pk_add_f16 v116, v144, v148
    v_pk_add_f16 v117, v145, v149
    v_mfma_f32_16x16x32_f16 a[244:247], v[220:223], v[72:75], a[244:247]
    ds_read_b128 v[108:111], v8 offset:27648
    v_pk_add_f16 v118, v146, v150
    s_cbranch_scc0 L_loop
    s_bitcmp0_b32 s84, 1
    s_cbranch_scc1 L_brk
L_tail:
    v_mfma_f32_16x16x32_f16 a[0:3], v[128:131], v[16:19], a[0:3]
    s_add_u32 s40, s40, 12288
    v_pk_add_f16 v119, v147, v151
    v_pk_add_f16 v148, v140, v148
    v_mfma_f32_16x16x32_f16 a[32:35], v[140:143], v[16:19], a[32:35]
    buffer_load_dwordx4 v[200:203], v1, s[4:7], s40 offen offset:0 sc1
    v_pk_add_f16 v149, v141, v149
    v_mfma_f32_16x16x32_f16 a[8:11], v[132:135], v[20:23], a[8:11]
    v_pk_add_f16 v150, v142, v150
    v_pk_add_f16 v151, v143, v151
    v_mfma_f32_16x16x32_f16 a[40:43], v[144:147], v[20:23], a[40:43]
    s_waitcnt lgkmcnt(4)
    v_pk_fma_f16 v48, v88, s42, v80
    v_pk_fma_f16 v49, v89, s42, v81
    v_mfma_f32_16x16x32_f16 a[24:27], v[112:115], v[28:31], a[24:27]
    buffer_load_dwordx4 v[204:207], v1, s[4:7], s40 offen offset:1024 sc1
    v_pk_fma_f16 v50, v90, s42, v82
    v_mfma_f32_16x16x32_f16 a[56:59], v[116:119], v[28:31], a[56:59]
    v_pk_fma_f16 v51, v91, s42, v83
    v_pk_fma_f16 v60, v92, s42, v84
    v_mfma_f32_16x16x32_f16 a[16:19], v[136:139], v[24:27], a[16:19]
    v_pk_fma_f16 v61, v93, s42, v85
    v_pk_fma_f16 v62, v94, s42, v86
    v_mfma_f32_16x16x32_f16 a[48:51], v[148:151], v[24:27], a[48:51]
    s_waitcnt vmcnt(11) lgkmcnt(0)
    v_pk_fma_f16 v63, v95, s42, v87
    v_pk_add_f16 v52, v48, v60
    v_mfma_f32_16x16x32_f16 a[4:7], v[128:131], v[32:35], a[4:7]
    buffer_load_dwordx4 v[208:211], v1, s[4:7], s40 offen offset:2048 sc1
    v_pk_add_f16 v53, v49, v61
    v_mfma_f32_16x16x32_f16 a[36:39], v[140:143], v[32:35], a[36:39]
    s_barrier
    v_pk_add_f16 v54, v50, v62
    v_pk_add_f16 v55, v51, v63
    v_mfma_f32_16x16x32_f16 a[28:31], v[112:115], v[44:47], a[28:31]
    ds_read_b128 v[80:83], v5 offset:0
    v_pk_add_f16 v56, v48, v60 neg_lo:[0,1] neg_hi:[0,1]
    v_mfma_f32_16x16x32_f16 a[60:63], v[116:119], v[44:47], a[60:63]
    s_add_u32 s40, s40, 12288
    v_pk_add_f16 v57, v49, v61 neg_lo:[0,1] neg_hi:[0,1]
    v_mfma_f32_16x16x32_f16 a[12:15], v[132:135], v[36:39], a[12:15]
    v_pk_add_f16 v58, v50, v62 neg_lo:[0,1] neg_hi:[0,1]
    v_pk_add_f16 v59, v51, v63 neg_lo:[0,1] neg_hi:[0,1]
    v_mfma_f32_16x16x32_f16 a[44:47], v[144:147], v[36:39], a[44:47]
    ds_read_b128 v[88:91], v7 offset:0
    v_pk_fma_f16 v64, v104, s42, v96
    v_mfma_f32_16x16x32_f16 a[20:23], v[136:139], v[40:43], a[20:23]
    v_pk_fma_f16 v65, v105, s42, v97
    v_pk_fma_f16 v66, v106, s42, v98
    v_mfma_f32_16x16x32_f16 a[52:55], v[148:151], v[40:43], a[52:55]
    buffer_load_dwordx4 v[212:215], v1, s[4:7], s40 offen offset:0 sc1
    v_pk_fma_f16 v67, v107, s42, v99
    v_mfma_f32_16x16x32_f16 a[64:67], v[128:131], v[48:51], a[64:67]
    ds_read_b128 v[84:87], v5 offset:1024
    v_pk_fma_f16 v76, v108, s42, v100
    v_mfma_f32_16x16x32_f16 a[96:99], v[140:143], v[48:51], a[96:99]
    v_pk_fma_f16 v77, v109, s42, v101
    v_pk_fma_f16 v78, v110, s42, v102
    v_mfma_f32_16x16x32_f16 a[88:91], v[112:115], v[60:63], a[88:91]
    buffer_load_dwordx4 v[216:219], v1, s[4:7], s40 offen offset:1024 sc1
    v_pk_fma_f16 v79, v111, s42, v103
    v_mfma_f32_16x16x32_f16 a[120:123], v[116:119], v[60:63], a[120:123]
    ds_read_b128 v[92:95], v7 offset:1024
    v_pk_add_f16 v68, v64, v76
    v_mfma_f32_16x16x32_f16 a[72:75], v[132:135], v[52:55], a[72:75]
    v_pk_add_f16 v69, v65, v77
    v_pk_add_f16 v70, v66, v78
    v_mfma_f32_16x16x32_f16 a[104:107], v[144:147], v[52:55], a[104:107]
    buffer_load_dwordx4 v[220:223], v1, s[4:7], s40 offen offset:2048 sc1
    v_pk_add_f16 v71, v67, v79
    v_mfma_f32_16x16x32_f16 a[80:83], v[136:139], v[56:59], a[80:83]
    ds_read_b128 v[96:99], v5 offset:2048
    v_pk_add_f16 v72, v64, v76 neg_lo:[0,1] neg_hi:[0,1]
    v_mfma_f32_16x16x32_f16 a[112:115], v[148:151], v[56:59], a[112:115]
    v_pk_add_f16 v73, v65, v77 neg_lo:[0,1] neg_hi:[0,1]
    v_pk_add_f16 v74, v66, v78 neg_lo:[0,1] neg_hi:[0,1]
    v_mfma_f32_16x16x32_f16 a[68:71], v[128:131], v[64:67], a[68:71]
    s_waitcnt vmcnt(22)
    v_pk_add_f16 v75, v67, v79 neg_lo:[0,1] neg_hi:[0,1]
    v_pk_add_f16 v120, v156, v160
    v_mfma_f32_16x16x32_f16 a[100:103], v[140:143], v[64:67], a[100:103]
    ds_read_b128 v[104:107], v7 offset:2048
    v_pk_add_f16 v121, v157, v161
    v_mfma_f32_16x16x32_f16 a[92:95], v[112:115], v[76:79], a[92:95]
    v_pk_add_f16 v122, v158, v162
    v_mfma_f32_16x16x32_f16 a[124:127], v[116:119], v[76:79], a[124:127]
    v_pk_add_f16 v123, v159, v163
    v_pk_add_f16 v160, v152, v160
    v_mfma_f32_16x16x32_f16 a[76:79], v[132:135], v[68:71], a[76:79]
    ds_read_b128 v[100:103], v5 offset:3072
    v_pk_add_f16 v161, v153, v161
    v_mfma_f32_16x16x32_f16 a[108:111], v[144:147], v[68:71], a[108:111]
    v_pk_add_f16 v162, v154, v162
    v_pk_add_f16 v163, v155, v163
    v_mfma_f32_16x16x32_f16 a[84:87], v[136:139], v[72:75], a[84:87]
    s_waitcnt vmcnt(12)
    v_pk_add_f16 v124, v168, v172
    v_pk_add_f16 v125, v169, v173
    v_mfma_f32_16x16x32_f16 a[116:119], v[148:151], v[72:75], a[116:119]
    ds_read_b128 v[108:111], v7 offset:3072
L_pad0:
    s_cbranch_execz L_padB
    s_nop 0
    v_pk_add_f16 v126, v170, v174
    v_mfma_f32_16x16x32_f16 a[128:131], v[152:155], v[16:19], a[128:131]
    v_pk_add_f16 v127, v171, v175
    v_pk_add_f16 v172, v164, v172
    v_mfma_f32_16x16x32_f16 a[160:163], v[164:167], v[16:19], a[160:163]
    v_pk_add_f16 v173, v165, v173
    v_mfma_f32_16x16x32_f16 a[136:139], v[156:159], v[20:23], a[136:139]
    v_pk_add_f16 v174, v166, v174
    v_pk_add_f16 v175, v167, v175
    v_mfma_f32_16x16x32_f16 a[168:171], v[168:171], v[20:23], a[168:171]
    s_waitcnt lgkmcnt(4)
    v_pk_fma_f16 v16, v88, s42, v80
    v_pk_fma_f16 v17, v89, s42, v81
    v_mfma_f32_16x16x32_f16 a[152:155], v[120:123], v[28:31], a[152:155]
    v_pk_fma_f16 v18, v90, s42, v82
    v_mfma_f32_16x16x32_f16 a[184:187], v[124:127], v[28:31], a[184:187]
    v_pk_fma_f16 v19, v91, s42, v83
    v_pk_fma_f16 v28, v92, s42, v84
    v_mfma_f32_16x16x32_f16 a[144:147], v[160:163], v[24:27], a[144:147]
    v_pk_fma_f16 v29, v93, s42, v85
    v_pk_fma_f16 v30, v94, s42, v86
    v_mfma_f32_16x16x32_f16 a[176:179], v[172:175], v[24:27], a[176:179]
    v_pk_fma_f16 v31, v95, s42, v87
    v_pk_add_f16 v20, v16, v28
    v_mfma_f32_16x16x32_f16 a[132:135], v[152:155], v[32:35], a[132:135]
    v_pk_add_f16 v21, v17, v29
    v_mfma_f32_16x16x32_f16 a[164:167], v[164:167], v[32:35], a[164:167]
    v_pk_add_f16 v22, v18, v30
    v_pk_add_f16 v23, v19, v31
    v_mfma_f32_16x16x32_f16 a[156:159], v[120:123], v[44:47], a[156:159]
    ds_read_b128 v[80:83], v6 offset:0
    v_pk_add_f16 v24, v16, v28 neg_lo:[0,1] neg_hi:[0,1]
    v_mfma_f32_16x16x32_f16 a[188:191], v[124:127], v[44:47], a[188:191]
    v_pk_add_f16 v25, v17, v29 neg_lo:[0,1] neg_hi:[0,1]
    v_mfma_f32_16x16x32_f16 a[140:143], v[156:159], v[36:39], a[140:143]
    s_waitcnt lgkmcnt(1)
    v_pk_add_f16 v26, v18, v30 neg_lo:[0,1] neg_hi:[0,1]
    v_pk_add_f16 v27, v19, v31 neg_lo:[0,1] neg_hi:[0,1]
    v_mfma_f32_16x16x32_f16 a[172:175], v[168:171], v[36:39], a[172:175]
    ds_read_b128 v[88:91], v8 offset:0
    v_pk_fma_f16 v32, v104, s42, v96
    v_mfma_f32_16x16x32_f16 a[148:151], v[160:163], v[40:43], a[148:151]
    v_pk_fma_f16 v33, v105, s42, v97
    v_pk_fma_f16 v34, v106, s42, v98
    v_mfma_f32_16x16x32_f16 a[180:183], v[172:175], v[40:43], a[180:183]
    v_pk_fma_f16 v35, v107, s42, v99
    v_mfma_f32_16x16x32_f16 a[192:195], v[152:155], v[48:51], a[192:195]
    ds_read_b128 v[84:87], v6 offset:1024
    v_pk_fma_f16 v44, v108, s42, v100
    v_mfma_f32_16x16x32_f16 a[224:227], v[164:167], v[48:51], a[224:227]
    v_pk_fma_f16 v45, v109, s42, v101
    v_pk_fma_f16 v46, v110, s42, v102
    v_mfma_f32_16x16x32_f16 a[216:219], v[120:123], v[60:63], a[216:219]
    v_pk_fma_f16 v47, v111, s42, v103
    v_mfma_f32_16x16x32_f16 a[248:251], v[124:127], v[60:63], a[248:251]
    ds_read_b128 v[92:95], v8 offset:1024
    v_pk_add_f16 v36, v32, v44
    v_mfma_f32_16x16x32_f16 a[200:203], v[156:159], v[52:55], a[200:203]
    v_pk_add_f16 v37, v33, v45
    v_pk_add_f16 v38, v34, v46
    v_mfma_f32_16x16x32_f16 a[232:235], v[168:171], v[52:55], a[232:235]
    v_pk_add_f16 v39, v35, v47
    v_mfma_f32_16x16x32_f16 a[208:211], v[160:163], v[56:59], a[208:211]
    ds_read_b128 v[96:99], v6 offset:2048
    v_pk_add_f16 v40, v32, v44 neg_lo:[0,1] neg_hi:[0,1]
    v_mfma_f32_16x16x32_f16 a[240:243], v[172:175], v[56:59], a[240:243]
    v_pk_add_f16 v41, v33, v45 neg_lo:[0,1] neg_hi:[0,1]
    v_pk_add_f16 v42, v34, v46 neg_lo:[0,1] neg_hi:[0,1]
    v_mfma_f32_16x16x32_f16 a[196:199], v[152:155], v[64:67], a[196:199]
    s_waitcnt vmcnt(9)
    v_pk_add_f16 v43, v35, v47 neg_lo:[0,1] neg_hi:[0,1]
    v_pk_add_f16 v112, v180, v184
    v_mfma_f32_16x16x32_f16 a[228:231], v[164:167], v[64:67], a[228:231]
    ds_read_b128 v[104:107], v8 offset:2048
    v_pk_add_f16 v113, v181, v185
    v_mfma_f32_16x16x32_f16 a[220:223], v[120:123], v[76:79], a[220:223]
    v_pk_add_f16 v114, v182, v186
    v_mfma_f32_16x16x32_f16 a[252:255], v[124:127], v[76:79], a[252:255]
    v_pk_add_f16 v115, v183, v187
    v_pk_add_f16 v184, v176, v184
    v_mfma_f32_16x16x32_f16 a[204:207], v[156:159], v[68:71], a[204:207]
    ds_read_b128 v[100:103], v6 offset:3072
    v_pk_add_f16 v185, v177, v185
    v_mfma_f32_16x16x32_f16 a[236:239], v[168:171], v[68:71], a[236:239]
    v_pk_add_f16 v186, v178, v186
    v_pk_add_f16 v187, v179, v187
    v_mfma_f32_16x16x32_f16 a[212:215], v[160:163], v[72:75], a[212:215]
    s_waitcnt vmcnt(6)
    v_pk_add_f16 v116, v192, v196
    v_pk_add_f16 v117, v193, v197
    v_mfma_f32_16x16x32_f16 a[244:247], v[172:175], v[72:75], a[244:247]
    ds_read_b128 v[108:111], v8 offset:3072
    v_pk_add_f16 v118, v194, v198
    v_mfma_f32_16x16x32_f16 a[0:3], v[176:179], v[16:19], a[0:3]
    v_pk_add_f16 v119, v195, v199
    v_pk_add_f16 v196, v188, v196
    v_mfma_f32_16x16x32_f16 a[32:35], v[188:191], v[16:19], a[32:35]
    v_pk_add_f16 v197, v189, v197
    v_pk_add_f16 v198, v190, v198
    v_mfma_f32_16x16x32_f16 a[8:11], v[180:183], v[20:23], a[8:11]
    s_waitcnt lgkmcnt(4)
    v_pk_add_f16 v199, v191, v199
    v_pk_fma_f16 v48, v88, s42, v80
    v_mfma_f32_16x16x32_f16 a[40:43], v[192:195], v[20:23], a[40:43]
    v_pk_fma_f16 v49, v89, s42, v81
    v_pk_fma_f16 v50, v90, s42, v82
    v_mfma_f32_16x16x32_f16 a[24:27], v[112:115], v[28:31], a[24:27]
    v_pk_fma_f16 v51, v91, s42, v83
    v_pk_fma_f16 v60, v92, s42, v84
    v_mfma_f32_16x16x32_f16 a[56:59], v[116:119], v[28:31], a[56:59]
    v_pk_fma_f16 v61, v93, s42, v85
    v_pk_fma_f16 v62, v94, s42, v86
    v_mfma_f32_16x16x32_f16 a[16:19], v[184:187], v[24:27], a[16:19]
    v_pk_fma_f16 v63, v95, s42, v87
    v_pk_add_f16 v52, v48, v60
    v_mfma_f32_16x16x32_f16 a[48:51], v[196:199], v[24:27], a[48:51]
    v_pk_add_f16 v53, v49, v61
    v_pk_add_f16 v54, v50, v62
    v_mfma_f32_16x16x32_f16 a[4:7], v[176:179], v[32:35], a[4:7]
    v_pk_add_f16 v55, v51, v63
    v_pk_add_f16 v56, v48, v60 neg_lo:[0,1] neg_hi:[0,1]
    v_mfma_f32_16x16x32_f16 a[36:39], v[188:191], v[32:35], a[36:39]
    v_pk_add_f16 v57, v49, v61 neg_lo:[0,1] neg_hi:[0,1]
    v_pk_add_f16 v58, v50, v62 neg_lo:[0,1] neg_hi:[0,1]
    v_mfma_f32_16x16x32_f16 a[28:31], v[112:115], v[44:47], a[28:31]
    s_waitcnt lgkmcnt(0)
    v_pk_add_f16 v59, v51, v63 neg_lo:[0,1] neg_hi:[0,1]
    v_pk_fma_f16 v64, v104, s42, v96
    v_mfma_f32_16x16x32_f16 a[60:63], v[116:119], v[44:47], a[60:63]
    v_pk_fma_f16 v65, v105, s42, v97
    v_pk_fma_f16 v66, v106, s42, v98
    v_mfma_f32_16x16x32_f16 a[12:15], v[180:183], v[36:39], a[12:15]
    v_pk_fma_f16 v67, v107, s42, v99
    v_pk_fma_f16 v76, v108, s42, v100
    v_mfma_f32_16x16x32_f16 a[44:47], v[192:195], v[36:39], a[44:47]
    v_pk_fma_f16 v77, v109, s42, v101
    v_pk_fma_f16 v78, v110, s42, v102
    v_mfma_f32_16x16x32_f16 a[20:23], v[184:187], v[40:43], a[20:23]
    v_pk_fma_f16 v79, v111, s42, v103
    v_pk_add_f16 v68, v64, v76
    v_mfma_f32_16x16x32_f16 a[52:55], v[196:199], v[40:43], a[52:55]
    v_pk_add_f16 v69, v65, v77
    v_pk_add_f16 v70, v66, v78
    v_mfma_f32_16x16x32_f16 a[64:67], v[176:179], v[48:51], a[64:67]
    v_pk_add_f16 v71, v67, v79
    v_pk_add_f16 v72, v64, v76 neg_lo:[0,1] neg_hi:[0,1]
    v_mfma_f32_16x16x32_f16 a[96:99], v[188:191], v[48:51], a[96:99]
    v_pk_add_f16 v73, v65, v77 neg_lo:[0,1] neg_hi:[0,1]
    v_pk_add_f16 v74, v66, v78 neg_lo:[0,1] neg_hi:[0,1]
    v_mfma_f32_16x16x32_f16 a[88:91], v[112:115], v[60:63], a[88:91]
    s_waitcnt vmcnt(0)
    v_pk_add_f16 v75, v67, v79 neg_lo:[0,1] neg_hi:[0,1]
    v_pk_add_f16 v120, v204, v208
    v_mfma_f32_16x16x32_f16 a[120:123], v[116:119], v[60:63], a[120:123]
    v_pk_add_f16 v121, v205, v209
    v_pk_add_f16 v122, v206, v210
    v_mfma_f32_16x16x32_f16 a[72:75], v[180:183], v[52:55], a[72:75]
    v_pk_add_f16 v123, v207, v211
    v_pk_add_f16 v208, v200, v208
    v_mfma_f32_16x16x32_f16 a[104:107], v[192:195], v[52:55], a[104:107]
    v_pk_add_f16 v209, v201, v209
    v_pk_add_f16 v210, v202, v210
    v_mfma_f32_16x16x32_f16 a[80:83], v[184:187], v[56:59], a[80:83]
    v_pk_add_f16 v211, v203, v211
    v_pk_add_f16 v124, v216, v220
    v_mfma_f32_16x16x32_f16 a[112:115], v[196:199], v[56:59], a[112:115]
    v_pk_add_f16 v125, v217, v221
    v_pk_add_f16 v126, v218, v222
    v_mfma_f32_16x16x32_f16 a[68:71], v[176:179], v[64:67], a[68:71]
    v_pk_add_f16 v127, v219, v223
    v_pk_add_f16 v220, v212, v220
    v_mfma_f32_16x16x32_f16 a[100:103], v[188:191], v[64:67], a[100:103]
    v_pk_add_f16 v221, v213, v221
    v_pk_add_f16 v222, v214, v222
    v_mfma_f32_16x16x32_f16 a[92:95], v[112:115], v[76:79], a[92:95]
    v_pk_add_f16 v223, v215, v223
    v_accvgpr_read_b32 v136, a8
    v_mfma_f32_16x16x32_f16 a[124:127], v[116:119], v[76:79], a[124:127]
    v_accvgpr_read_b32 v137, a9
    v_accvgpr_read_b32 v138, a10
    v_mfma_f32_16x16x32_f16 a[76:79], v[180:183], v[68:71], a[76:79]
    s_bitcmp1_b32 s84, 2
    v_accvgpr_read_b32 v139, a11
    v_accvgpr_read_b32 v144, a16
    v_mfma_f32_16x16x32_f16 a[108:111], v[192:195], v[68:71], a[108:111]
    v_accvgpr_read_b32 v145, a17
    v_accvgpr_read_b32 v146, a18
    v_mfma_f32_16x16x32_f16 a[84:87], v[184:187], v[72:75], a[84:87]
    v_accvgpr_read_b32 v147, a19
    v_accvgpr_read_b32 v140, a12
    v_mfma_f32_16x16x32_f16 a[116:119], v[196:199], v[72:75], a[116:119]
    v_accvgpr_read_b32 v141, a13
    v_accvgpr_read_b32 v142, a14
    s_cbranch_scc1 L_epi1
L_epi0:
    v_mfma_f32_16x16x32_f16 a[128:131], v[200:203], v[16:19], a[128:131]
    v_add_u32 v169, s24, v9
    v_lshrrev_b32 v167, 8, v9
    v_mfma_f32_16x16x32_f16 a[160:163], v[212:215], v[16:19], a[160:163]
    v_mul_u32_u24 v167, 196608, v167
    v_and_b32 v168, 0xf0, v9
    v_mfma_f32_16x16x32_f16 a[136:139], v[204:207], v[20:23], a[136:139]
    v_add3_u32 v167, v167, v168, s46
    v_add_u32 v164, s25, v9
    v_mfma_f32_16x16x32_f16 a[168:171], v[216:219], v[20:23], a[168:171]
    v_add_u32 v165, s26, v9
    v_add_u32 v166, s27, v9
    v_mfma_f32_16x16x32_f16 a[152:155], v[120:123], v[28:31], a[152:155]
    ds_read_b128 v[176:179], v169 offset:0
    v_and_b32 v168, 0xf0, v9
    v_mfma_f32_16x16x32_f16 a[184:187], v[124:127], v[28:31], a[184:187]
    ds_read_b128 v[180:183], v169 offset:4096
    v_and_b32 v170, 0xff, v12
    v_mfma_f32_16x16x32_f16 a[144:147], v[208:211], v[24:27], a[144:147]
    ds_read_b128 v[184:187], v169 offset:8192
    v_lshl_add_u32 v168, v168, 4, v170
    v_mfma_f32_16x16x32_f16 a[176:179], v[220:223], v[24:27], a[176:179]
    ds_read_b128 v[188:191], v169 offset:12288
    v_accvgpr_read_b32 v143, a15
    v_mfma_f32_16x16x32_f16 a[132:135], v[200:203], v[32:35], a[132:135]
    ds_read_b128 v[192:195], v169 offset:16384
    v_accvgpr_read_b32 v148, a20
    v_mfma_f32_16x16x32_f16 a[164:167], v[212:215], v[32:35], a[164:167]
    ds_read_b128 v[196:199], v169 offset:20480
    v_accvgpr_read_b32 v149, a21
    v_mfma_f32_16x16x32_f16 a[156:159], v[120:123], v[44:47], a[156:159]
    s_lshl3_add_u32 s37, s34, s35
    v_accvgpr_read_b32 v150, a22
    v_accvgpr_read_b32 v151, a23
    v_mfma_f32_16x16x32_f16 a[188:191], v[124:127], v[44:47], a[188:191]
    s_lshl_b32 s37, s37, 12
    v_accvgpr_read_b32 v128, a0
    v_accvgpr_read_b32 v129, a1
    v_mfma_f32_16x16x32_f16 a[140:143], v[204:207], v[36:39], a[140:143]
    s_add_u32 s37, s37, 131072
    v_accvgpr_read_b32 v130, a2
    v_accvgpr_read_b32 v131, a3
    v_mfma_f32_16x16x32_f16 a[172:175], v[216:219], v[36:39], a[172:175]
    v_accvgpr_read_b32 v132, a4
    v_accvgpr_read_b32 v133, a5
    v_mfma_f32_16x16x32_f16 a[148:151], v[208:211], v[40:43], a[148:151]
    v_accvgpr_read_b32 v134, a6
    v_accvgpr_read_b32 v135, a7
    v_mfma_f32_16x16x32_f16 a[180:183], v[220:223], v[40:43], a[180:183]
    s_waitcnt lgkmcnt(0)
    v_accvgpr_read_b32 v152, a24
    v_accvgpr_read_b32 v153, a25
    v_mfma_f32_16x16x32_f16 a[192:195], v[200:203], v[48:51], a[192:195]
    v_accvgpr_read_b32 v154, a26
    v_accvgpr_read_b32 v155, a27
    v_mfma_f32_16x16x32_f16 a[224:227], v[212:215], v[48:51], a[224:227]
    v_accvgpr_read_b32 v156, a28
    v_accvgpr_read_b32 v157, a29
    v_mfma_f32_16x16x32_f16 a[216:219], v[120:123], v[60:63], a[216:219]
    v_accvgpr_read_b32 v158, a30
    v_accvgpr_read_b32 v159, a31
    v_mfma_f32_16x16x32_f16 a[248:251], v[124:127], v[60:63], a[248:251]
    v_accvgpr_read_b32 v24, a40
    v_accvgpr_read_b32 v25, a41
    v_mfma_f32_16x16x32_f16 a[200:203], v[204:207], v[52:55], a[200:203]
    v_accvgpr_read_b32 v26, a42
    v_accvgpr_read_b32 v27, a43
    v_mfma_f32_16x16x32_f16 a[232:235], v[216:219], v[52:55], a[232:235]
    v_accvgpr_read_b32 v32, a48
    v_accvgpr_read_b32 v33, a49
    v_mfma_f32_16x16x32_f16 a[208:211], v[208:211], v[56:59], a[208:211]
    v_accvgpr_read_b32 v34, a50
    v_accvgpr_read_b32 v35, a51
    v_mfma_f32_16x16x32_f16 a[240:243], v[220:223], v[56:59], a[240:243]
    v_accvgpr_read_b32 v28, a44
    v_accvgpr_read_b32 v29, a45
    v_mfma_f32_16x16x32_f16 a[196:199], v[200:203], v[64:67], a[196:199]
    v_accvgpr_read_b32 v30, a46
    v_accvgpr_read_b32 v31, a47
    v_mfma_f32_16x16x32_f16 a[228:231], v[212:215], v[64:67], a[228:231]
    v_accvgpr_read_b32 v36, a52
    v_accvgpr_read_b32 v37, a53
    v_mfma_f32_16x16x32_f16 a[220:223], v[120:123], v[76:79], a[220:223]
    v_accvgpr_read_b32 v38, a54
    v_accvgpr_read_b32 v39, a55
    v_mfma_f32_16x16x32_f16 a[252:255], v[124:127], v[76:79], a[252:255]
    v_accvgpr_read_b32 v16, a32
    v_accvgpr_read_b32 v17, a33
    v_mfma_f32_16x16x32_f16 a[204:207], v[204:207], v[68:71], a[204:207]
    v_accvgpr_read_b32 v18, a34
    v_accvgpr_read_b32 v19, a35
    v_mfma_f32_16x16x32_f16 a[236:239], v[216:219], v[68:71], a[236:239]
    v_accvgpr_read_b32 v20, a36
    v_accvgpr_read_b32 v21, a37
    v_mfma_f32_16x16x32_f16 a[212:215], v[208:211], v[72:75], a[212:215]
    v_accvgpr_read_b32 v22, a38
    v_accvgpr_read_b32 v23, a39
    v_mfma_f32_16x16x32_f16 a[244:247], v[220:223], v[72:75], a[244:247]
    v_accvgpr_read_b32 v40, a56
    v_accvgpr_read_b32 v41, a57
L_mfma_done0:
    buffer_load_dwordx4 v[208:211], v12, s[16:19], 0 offen offset:0 sc1
    buffer_load_dwordx4 v[212:215], v12, s[16:19], 0 offen offset:16 sc1
    buffer_load_dwordx4 v[216:219], v168, s[16:19], s37 offen offset:0 sc1
    buffer_load_dwordx4 v[220:223], v168, s[16:19], s37 offen offset:16 sc1
    buffer_load_dwordx4 v[48:51], v13, s[16:19], 0 offen sc1
    v_add_u32_e64 v72, s28, v9
    v_pk_add_f32 v[88:89], v[136:137], v[144:145]
    v_pk_add_f32 v[90:91], v[138:139], v[146:147]
    v_pk_add_f32 v[80:81], v[136:137], v[144:145] neg_lo:[0,1] neg_hi:[0,1]
    v_pk_add_f32 v[82:83], v[138:139], v[146:147] neg_lo:[0,1] neg_hi:[0,1]
    v_pk_add_f32 v[104:105], v[140:141], v[148:149]
    v_pk_add_f32 v[106:107], v[142:143], v[150:151]
    v_pk_add_f32 v[96:97], v[140:141], v[148:149] neg_lo:[0,1] neg_hi:[0,1]
    v_pk_add_f32 v[98:99], v[142:143], v[150:151] neg_lo:[0,1] neg_hi:[0,1]
    v_pk_add_f32 v[88:89], v[88:89], v[128:129] neg_lo:[0,1] neg_hi:[0,1]
    v_pk_add_f32 v[90:91], v[90:91], v[130:131] neg_lo:[0,1] neg_hi:[0,1]
    v_pk_add_f32 v[80:81], v[80:81], v[152:153] neg_lo:[0,1] neg_hi:[0,1]
    v_pk_add_f32 v[82:83], v[82:83], v[154:155] neg_lo:[0,1] neg_hi:[0,1]
    v_pk_add_f32 v[104:105], v[104:105], v[132:133] neg_lo:[0,1] neg_hi:[0,1]
    v_pk_add_f32 v[106:107], v[106:107], v[134:135] neg_lo:[0,1] neg_hi:[0,1]
    v_pk_add_f32 v[96:97], v[96:97], v[156:157] neg_lo:[0,1] neg_hi:[0,1]
    v_pk_add_f32 v[98:99], v[98:99], v[158:159] neg_lo:[0,1] neg_hi:[0,1]
    v_pk_add_f32 v[88:89], v[88:89], v[132:133]
    v_pk_add_f32 v[90:91], v[90:91], v[134:135]
    v_pk_add_f32 v[96:97], v[96:97], v[152:153]
    v_pk_add_f32 v[98:99], v[98:99], v[154:155]
    v_add_f32_dpp v80, v156, v80 row_shr:1 row_mask:0xf bank_mask:0xf bound_ctrl:1
    v_add_f32_dpp v81, v157, v81 row_shr:1 row_mask:0xf bank_mask:0xf bound_ctrl:1
    v_add_f32_dpp v82, v158, v82 row_shr:1 row_mask:0xf bank_mask:0xf bound_ctrl:1
    v_add_f32_dpp v83, v159, v83 row_shr:1 row_mask:0xf bank_mask:0xf bound_ctrl:1
    v_add_f32_dpp v104, v128, v104 row_shl:1 row_mask:0xf bank_mask:0xf bound_ctrl:1
    v_add_f32_dpp v105, v129, v105 row_shl:1 row_mask:0xf bank_mask:0xf bound_ctrl:1
    v_add_f32_dpp v106, v130, v106 row_shl:1 row_mask:0xf bank_mask:0xf bound_ctrl:1
    v_add_f32_dpp v107, v131, v107 row_shl:1 row_mask:0xf bank_mask:0xf bound_ctrl:1
    v_accvgpr_read_b32 v42, a58
    v_accvgpr_read_b32 v43, a59
    v_accvgpr_read_b32 v44, a60
    ds_write_b128 v164, v[88:91] offset:2048
    ds_write_b128 v164, v[96:99] offset:4096
    v_accvgpr_read_b32 v45, a61
    v_accvgpr_read_b32 v46, a62
    v_accvgpr_read_b32 v47, a63
    v_pk_add_f32 v[92:93], v[24:25], v[32:33]
    v_pk_add_f32 v[94:95], v[26:27], v[34:35]
    v_pk_add_f32 v[84:85], v[24:25], v[32:33] neg_lo:[0,1] neg_hi:[0,1]
    v_pk_add_f32 v[86:87], v[26:27], v[34:35] neg_lo:[0,1] neg_hi:[0,1]
    v_pk_add_f32 v[108:109], v[28:29], v[36:37]
    v_pk_add_f32 v[110:111], v[30:31], v[38:39]
    v_pk_add_f32 v[100:101], v[28:29], v[36:37] neg_lo:[0,1] neg_hi:[0,1]
    v_pk_add_f32 v[102:103], v[30:31], v[38:39] neg_lo:[0,1] neg_hi:[0,1]
    v_pk_add_f32 v[92:93], v[92:93], v[16:17] neg_lo:[0,1] neg_hi:[0,1]
    v_pk_add_f32 v[94:95], v[94:95], v[18:19] neg_lo:[0,1] neg_hi:[0,1]
    v_pk_add_f32 v[84:85], v[84:85], v[40:41] neg_lo:[0,1] neg_hi:[0,1]
    v_pk_add_f32 v[86:87], v[86:87], v[42:43] neg_lo:[0,1] neg_hi:[0,1]
    v_pk_add_f32 v[108:109], v[108:109], v[20:21] neg_lo:[0,1] neg_hi:[0,1]
    v_pk_add_f32 v[110:111], v[110:111], v[22:23] neg_lo:[0,1] neg_hi:[0,1]
    ds_write_b128 v164, v[80:83] offset:0
    ds_write_b128 v164, v[104:107] offset:6144
    v_pk_add_f32 v[100:101], v[100:101], v[44:45] neg_lo:[0,1] neg_hi:[0,1]
    v_pk_add_f32 v[102:103], v[102:103], v[46:47] neg_lo:[0,1] neg_hi:[0,1]
    v_pk_add_f32 v[92:93], v[92:93], v[20:21]
    v_pk_add_f32 v[94:95], v[94:95], v[22:23]
    v_pk_add_f32 v[100:101], v[100:101], v[40:41]
    v_pk_add_f32 v[102:103], v[102:103], v[42:43]
    v_add_f32_dpp v84, v44, v84 row_shr:1 row_mask:0xf bank_mask:0xf bound_ctrl:1
    v_add_f32_dpp v85, v45, v85 row_shr:1 row_mask:0xf bank_mask:0xf bound_ctrl:1
    v_add_f32_dpp v86, v46, v86 row_shr:1 row_mask:0xf bank_mask:0xf bound_ctrl:1
    v_add_f32_dpp v87, v47, v87 row_shr:1 row_mask:0xf bank_mask:0xf bound_ctrl:1
    v_add_f32_dpp v108, v16, v108 row_shl:1 row_mask:0xf bank_mask:0xf bound_ctrl:1
    v_add_f32_dpp v109, v17, v109 row_shl:1 row_mask:0xf bank_mask:0xf bound_ctrl:1
    v_add_f32_dpp v110, v18, v110 row_shl:1 row_mask:0xf bank_mask:0xf bound_ctrl:1
    v_add_f32_dpp v111, v19, v111 row_shl:1 row_mask:0xf bank_mask:0xf bound_ctrl:1
    v_accvgpr_read_b32 v24, a72
    v_accvgpr_read_b32 v25, a73
    v_accvgpr_read_b32 v26, a74
    v_accvgpr_read_b32 v27, a75
    v_accvgpr_read_b32 v32, a80
    v_accvgpr_read_b32 v33, a81
    ds_write_b128 v164, v[92:95] offset:3072
    ds_write_b128 v164, v[100:103] offset:5120
    buffer_store_dwordx4 v[176:179], v167, s[48:51], s58 offen offset:0 sc1
    v_accvgpr_read_b32 v34, a82
    v_accvgpr_read_b32 v35, a83
    v_accvgpr_read_b32 v28, a76
    v_accvgpr_read_b32 v29, a77
    v_accvgpr_read_b32 v30, a78
    v_accvgpr_read_b32 v31, a79
    v_accvgpr_read_b32 v36, a84
    v_accvgpr_read_b32 v37, a85
    v_accvgpr_read_b32 v38, a86
    v_accvgpr_read_b32 v39, a87
    v_accvgpr_read_b32 v16, a64
    v_accvgpr_read_b32 v17, a65
    v_accvgpr_read_b32 v18, a66
    v_accvgpr_read_b32 v19, a67
    v_accvgpr_read_b32 v20, a68
    v_accvgpr_read_b32 v21, a69
    v_accvgpr_read_b32 v22, a70
    v_accvgpr_read_b32 v23, a71
    v_accvgpr_read_b32 v40, a88
    v_accvgpr_read_b32 v41, a89
    v_accvgpr_read_b32 v42, a90
    v_accvgpr_read_b32 v43, a91
    v_accvgpr_read_b32 v44, a92
    v_accvgpr_read_b32 v45, a93
    v_accvgpr_read_b32 v46, a94
    v_accvgpr_read_b32 v47, a95
    v_pk_add_f32 v[88:89], v[24:25], v[32:33]
    v_pk_add_f32 v[90:91], v[26:27], v[34:35]
    v_pk_add_f32 v[80:81], v[24:25], v[32:33] neg_lo:[0,1] neg_hi:[0,1]
    v_pk_add_f32 v[82:83], v[26:27], v[34:35] neg_lo:[0,1] neg_hi:[0,1]
    ds_write_b128 v164, v[84:87] offset:1024
    ds_write_b128 v164, v[108:111] offset:7168
    buffer_store_dwordx4 v[180:183], v167, s[48:51], s58 offen offset:1024 sc1
    v_pk_add_f32 v[104:105], v[28:29], v[36:37]
    v_pk_add_f32 v[106:107], v[30:31], v[38:39]
    v_pk_add_f32 v[96:97], v[28:29], v[36:37] neg_lo:[0,1] neg_hi:[0,1]
    v_pk_add_f32 v[98:99], v[30:31], v[38:39] neg_lo:[0,1] neg_hi:[0,1]
    v_pk_add_f32 v[88:89], v[88:89], v[16:17] neg_lo:[0,1] neg_hi:[0,1]
    v_pk_add_f32 v[90:91], v[90:91], v[18:19] neg_lo:[0,1] neg_hi:[0,1]
    v_pk_add_f32 v[80:81], v[80:81], v[40:41] neg_lo:[0,1] neg_hi:[0,1]
    v_pk_add_f32 v[82:83], v[82:83], v[42:43] neg_lo:[0,1] neg_hi:[0,1]
    v_pk_add_f32 v[104:105], v[104:105], v[20:21] neg_lo:[0,1] neg_hi:[0,1]
    v_pk_add_f32 v[106:107], v[106:107], v[22:23] neg_lo:[0,1] neg_hi:[0,1]
    v_pk_add_f32 v[96:97], v[96:97], v[44:45] neg_lo:[0,1] neg_hi:[0,1]
    v_pk_add_f32 v[98:99], v[98:99], v[46:47] neg_lo:[0,1] neg_hi:[0,1]
    v_pk_add_f32 v[88:89], v[88:89], v[20:21]
    v_pk_add_f32 v[90:91], v[90:91], v[22:23]
    v_pk_add_f32 v[96:97], v[96:97], v[40:41]
    v_pk_add_f32 v[98:99], v[98:99], v[42:43]
    v_add_f32_dpp v80, v44, v80 row_shr:1 row_mask:0xf bank_mask:0xf bound_ctrl:1
    v_add_f32_dpp v81, v45, v81 row_shr:1 row_mask:0xf bank_mask:0xf bound_ctrl:1
    v_add_f32_dpp v82, v46, v82 row_shr:1 row_mask:0xf bank_mask:0xf bound_ctrl:1
    v_add_f32_dpp v83, v47, v83 row_shr:1 row_mask:0xf bank_mask:0xf bound_ctrl:1
    v_add_f32_dpp v104, v16, v104 row_shl:1 row_mask:0xf bank_mask:0xf bound_ctrl:1
    v_add_f32_dpp v105, v17, v105 row_shl:1 row_mask:0xf bank_mask:0xf bound_ctrl:1
    v_add_f32_dpp v106, v18, v106 row_shl:1 row_mask:0xf bank_mask:0xf bound_ctrl:1
    v_add_f32_dpp v107, v19, v107 row_shl:1 row_mask:0xf bank_mask:0xf bound_ctrl:1
    v_accvgpr_read_b32 v24, a104
    v_accvgpr_read_b32 v25, a105
    v_accvgpr_read_b32 v26, a106
    v_accvgpr_read_b32 v27, a107
    v_accvgpr_read_b32 v32, a112
    v_accvgpr_read_b32 v33, a113
    ds_write_b128 v165, v[88:91] offset:2048
    ds_write_b128 v165, v[96:99] offset:4096
    buffer_store_dwordx4 v[184:187], v167, s[48:51], s58 offen offset:2048 sc1
    v_accvgpr_read_b32 v34, a114
    v_accvgpr_read_b32 v35, a115
    v_accvgpr_read_b32 v28, a108
    v_accvgpr_read_b32 v29, a109
    v_accvgpr_read_b32 v30, a110
    v_accvgpr_read_b32 v31, a111
    v_accvgpr_read_b32 v36, a116
    v_accvgpr_read_b32 v37, a117
    v_accvgpr_read_b32 v38, a118
    v_accvgpr_read_b32 v39, a119
    v_accvgpr_read_b32 v16, a96
    v_accvgpr_read_b32 v17, a97
    v_accvgpr_read_b32 v18, a98
    v_accvgpr_read_b32 v19, a99
    v_accvgpr_read_b32 v20, a100
    v_accvgpr_read_b32 v21, a101
    v_accvgpr_read_b32 v22, a102
    v_accvgpr_read_b32 v23, a103
    v_accvgpr_read_b32 v40, a120
    v_accvgpr_read_b32 v41, a121
    v_accvgpr_read_b32 v42, a122
    v_accvgpr_read_b32 v43, a123
    v_accvgpr_read_b32 v44, a124
    v_accvgpr_read_b32 v45, a125
    v_accvgpr_read_b32 v46, a126
    v_accvgpr_read_b32 v47, a127
    v_pk_add_f32 v[92:93], v[24:25], v[32:33]
    v_pk_add_f32 v[94:95], v[26:27], v[34:35]
    v_pk_add_f32 v[84:85], v[24:25], v[32:33] neg_lo:[0,1] neg_hi:[0,1]
    v_pk_add_f32 v[86:87], v[26:27], v[34:35] neg_lo:[0,1] neg_hi:[0,1]
    ds_write_b128 v165, v[80:83] offset:0
    ds_write_b128 v165, v[104:107] offset:6144
    buffer_store_dwordx4 v[188:191], v167, s[48:51], s59 offen offset:0 sc1
    v_pk_add_f32 v[108:109], v[28:29], v[36:37]
    v_pk_add_f32 v[110:111], v[30:31], v[38:39]
    v_pk_add_f32 v[100:101], v[28:29], v[36:37] neg_lo:[0,1] neg_hi:[0,1]
    v_pk_add_f32 v[102:103], v[30:31], v[38:39] neg_lo:[0,1] neg_hi:[0,1]
    v_pk_add_f32 v[92:93], v[92:93], v[16:17] neg_lo:[0,1] neg_hi:[0,1]
    v_pk_add_f32 v[94:95], v[94:95], v[18:19] neg_lo:[0,1] neg_hi:[0,1]
    v_pk_add_f32 v[84:85], v[84:85], v[40:41] neg_lo:[0,1] neg_hi:[0,1]
    v_pk_add_f32 v[86:87], v[86:87], v[42:43] neg_lo:[0,1] neg_hi:[0,1]
    v_pk_add_f32 v[108:109], v[108:109], v[20:21] neg_lo:[0,1] neg_hi:[0,1]
    v_pk_add_f32 v[110:111], v[110:111], v[22:23] neg_lo:[0,1] neg_hi:[0,1]
    v_pk_add_f32 v[100:101], v[100:101], v[44:45] neg_lo:[0,1] neg_hi:[0,1]
    v_pk_add_f32 v[102:103], v[102:103], v[46:47] neg_lo:[0,1] neg_hi:[0,1]
    v_pk_add_f32 v[92:93], v[92:93], v[20:21]
    v_pk_add_f32 v[94:95], v[94:95], v[22:23]
    v_pk_add_f32 v[100:101], v[100:101], v[40:41]
    v_pk_add_f32 v[102:103], v[102:103], v[42:43]
    v_add_f32_dpp v84, v44, v84 row_shr:1 row_mask:0xf bank_mask:0xf bound_ctrl:1
    v_add_f32_dpp v85, v45, v85 row_shr:1 row_mask:0xf bank_mask:0xf bound_ctrl:1
    v_add_f32_dpp v86, v46, v86 row_shr:1 row_mask:0xf bank_mask:0xf bound_ctrl:1
    v_add_f32_dpp v87, v47, v87 row_shr:1 row_mask:0xf bank_mask:0xf bound_ctrl:1
    v_add_f32_dpp v108, v16, v108 row_shl:1 row_mask:0xf bank_mask:0xf bound_ctrl:1
    v_add_f32_dpp v109, v17, v109 row_shl:1 row_mask:0xf bank_mask:0xf bound_ctrl:1
    v_add_f32_dpp v110, v18, v110 row_shl:1 row_mask:0xf bank_mask:0xf bound_ctrl:1
    v_add_f32_dpp v111, v19, v111 row_shl:1 row_mask:0xf bank_mask:0xf bound_ctrl:1
    v_accvgpr_read_b32 v24, a136
    v_accvgpr_read_b32 v25, a137
    v_accvgpr_read_b32 v26, a138
    v_accvgpr_read_b32 v27, a139
    v_accvgpr_read_b32 v32, a144
    v_accvgpr_read_b32 v33, a145
    ds_write_b128 v165, v[92:95] offset:3072
    ds_write_b128 v165, v[100:103] offset:5120
    buffer_store_dwordx4 v[192:195], v167, s[48:51], s59 offen offset:1024 sc1
    v_accvgpr_read_b32 v34, a146
    v_accvgpr_read_b32 v35, a147
    v_accvgpr_read_b32 v28, a140
    v_accvgpr_read_b32 v29, a141
    v_accvgpr_read_b32 v30, a142
    v_accvgpr_read_b32 v31, a143
    v_accvgpr_read_b32 v36, a148
    v_accvgpr_read_b32 v37, a149
    v_accvgpr_read_b32 v38, a150
    v_accvgpr_read_b32 v39, a151
    v_accvgpr_read_b32 v16, a128
    v_accvgpr_read_b32 v17, a129
L_pad1:
    s_cbranch_execz L_padA
    s_nop 0
    v_accvgpr_read_b32 v18, a130
    v_accvgpr_read_b32 v19, a131
    v_accvgpr_read_b32 v20, a132
    v_accvgpr_read_b32 v21, a133
    v_accvgpr_read_b32 v22, a134
    v_accvgpr_read_b32 v23, a135
    v_accvgpr_read_b32 v40, a152
    v_accvgpr_read_b32 v41, a153
    v_accvgpr_read_b32 v42, a154
    v_accvgpr_read_b32 v43, a155
    v_accvgpr_read_b32 v44, a156
    v_accvgpr_read_b32 v45, a157
    v_accvgpr_read_b32 v46, a158
    v_accvgpr_read_b32 v47, a159
    v_pk_add_f32 v[88:89], v[24:25], v[32:33]
    v_pk_add_f32 v[90:91], v[26:27], v[34:35]
    v_pk_add_f32 v[80:81], v[24:25], v[32:33] neg_lo:[0,1] neg_hi:[0,1]
    v_pk_add_f32 v[82:83], v[26:27], v[34:35] neg_lo:[0,1] neg_hi:[0,1]
    ds_write_b128 v165, v[84:87] offset:1024
    ds_write_b128 v165, v[108:111] offset:7168
    buffer_store_dwordx4 v[196:199], v167, s[48:51], s59 offen offset:2048 sc1
    v_pk_add_f32 v[104:105], v[28:29], v[36:37]
    v_pk_add_f32 v[106:107], v[30:31], v[38:39]
    v_pk_add_f32 v[96:97], v[28:29], v[36:37] neg_lo:[0,1] neg_hi:[0,1]
    v_pk_add_f32 v[98:99], v[30:31], v[38:39] neg_lo:[0,1] neg_hi:[0,1]
    v_pk_add_f32 v[88:89], v[88:89], v[16:17] neg_lo:[0,1] neg_hi:[0,1]
    v_pk_add_f32 v[90:91], v[90:91], v[18:19] neg_lo:[0,1] neg_hi:[0,1]
    v_pk_add_f32 v[80:81], v[80:81], v[40:41] neg_lo:[0,1] neg_hi:[0,1]
    v_pk_add_f32 v[82:83], v[82:83], v[42:43] neg_lo:[0,1] neg_hi:[0,1]
    v_pk_add_f32 v[104:105], v[104:105], v[20:21] neg_lo:[0,1] neg_hi:[0,1]
    v_pk_add_f32 v[106:107], v[106:107], v[22:23] neg_lo:[0,1] neg_hi:[0,1]
    v_pk_add_f32 v[96:97], v[96:97], v[44:45] neg_lo:[0,1] neg_hi:[0,1]
    v_pk_add_f32 v[98:99], v[98:99], v[46:47] neg_lo:[0,1] neg_hi:[0,1]
    v_pk_add_f32 v[88:89], v[88:89], v[20:21]
    v_pk_add_f32 v[90:91], v[90:91], v[22:23]
    v_pk_add_f32 v[96:97], v[96:97], v[40:41]
    v_pk_add_f32 v[98:99], v[98:99], v[42:43]
    v_add_f32_dpp v80, v44, v80 row_shr:1 row_mask:0xf bank_mask:0xf bound_ctrl:1
    v_add_f32_dpp v81, v45, v81 row_shr:1 row_mask:0xf bank_mask:0xf bound_ctrl:1
    v_add_f32_dpp v82, v46, v82 row_shr:1 row_mask:0xf bank_mask:0xf bound_ctrl:1
    v_add_f32_dpp v83, v47, v83 row_shr:1 row_mask:0xf bank_mask:0xf bound_ctrl:1
    v_add_f32_dpp v104, v16, v104 row_shl:1 row_mask:0xf bank_mask:0xf bound_ctrl:1
    v_add_f32_dpp v105, v17, v105 row_shl:1 row_mask:0xf bank_mask:0xf bound_ctrl:1
    v_add_f32_dpp v106, v18, v106 row_shl:1 row_mask:0xf bank_mask:0xf bound_ctrl:1
    v_add_f32_dpp v107, v19, v107 row_shl:1 row_mask:0xf bank_mask:0xf bound_ctrl:1
    v_accvgpr_read_b32 v24, a168
    v_accvgpr_read_b32 v25, a169
    v_accvgpr_read_b32 v26, a170
    v_accvgpr_read_b32 v27, a171
    v_accvgpr_read_b32 v32, a176
    v_accvgpr_read_b32 v33, a177
    ds_write_b128 v166, v[88:91] offset:2048
    ds_write_b128 v166, v[96:99] offset:4096
    v_accvgpr_read_b32 v34, a178
    v_accvgpr_read_b32 v35, a179
    v_accvgpr_read_b32 v28, a172
    v_accvgpr_read_b32 v29, a173
    v_accvgpr_read_b32 v30, a174
    v_accvgpr_read_b32 v31, a175
    v_accvgpr_read_b32 v36, a180
    v_accvgpr_read_b32 v37, a181
    v_accvgpr_read_b32 v38, a182
    v_accvgpr_read_b32 v39, a183
    v_accvgpr_read_b32 v16, a160
    v_accvgpr_read_b32 v17, a161
    v_accvgpr_read_b32 v18, a162
    v_accvgpr_read_b32 v19, a163
    v_accvgpr_read_b32 v20, a164
    v_accvgpr_read_b32 v21, a165
    v_accvgpr_read_b32 v22, a166
    v_accvgpr_read_b32 v23, a167
    v_accvgpr_read_b32 v40, a184
    v_accvgpr_read_b32 v41, a185
    v_accvgpr_read_b32 v42, a186
    v_accvgpr_read_b32 v43, a187
    v_accvgpr_read_b32 v44, a188
    v_accvgpr_read_b32 v45, a189
    v_accvgpr_read_b32 v46, a190
    v_accvgpr_read_b32 v47, a191
    v_pk_add_f32 v[92:93], v[24:25], v[32:33]
    v_pk_add_f32 v[94:95], v[26:27], v[34:35]
    v_pk_add_f32 v[84:85], v[24:25], v[32:33] neg_lo:[0,1] neg_hi:[0,1]
    v_pk_add_f32 v[86:87], v[26:27], v[34:35] neg_lo:[0,1] neg_hi:[0,1]
    ds_write_b128 v166, v[80:83] offset:0
    ds_write_b128 v166, v[104:107] offset:6144
    v_pk_add_f32 v[108:109], v[28:29], v[36:37]
    v_pk_add_f32 v[110:111], v[30:31], v[38:39]
    v_pk_add_f32 v[100:101], v[28:29], v[36:37] neg_lo:[0,1] neg_hi:[0,1]
    v_pk_add_f32 v[102:103], v[30:31], v[38:39] neg_lo:[0,1] neg_hi:[0,1]
    v_pk_add_f32 v[92:93], v[92:93], v[16:17] neg_lo:[0,1] neg_hi:[0,1]
    v_pk_add_f32 v[94:95], v[94:95], v[18:19] neg_lo:[0,1] neg_hi:[0,1]
    v_pk_add_f32 v[84:85], v[84:85], v[40:41] neg_lo:[0,1] neg_hi:[0,1]
    v_pk_add_f32 v[86:87], v[86:87], v[42:43] neg_lo:[0,1] neg_hi:[0,1]
    v_pk_add_f32 v[108:109], v[108:109], v[20:21] neg_lo:[0,1] neg_hi:[0,1]
    v_pk_add_f32 v[110:111], v[110:111], v[22:23] neg_lo:[0,1] neg_hi:[0,1]
    v_pk_add_f32 v[100:101], v[100:101], v[44:45] neg_lo:[0,1] neg_hi:[0,1]
    v_pk_add_f32 v[102:103], v[102:103], v[46:47] neg_lo:[0,1] neg_hi:[0,1]
    v_pk_add_f32 v[92:93], v[92:93], v[20:21]
    v_pk_add_f32 v[94:95], v[94:95], v[22:23]
    v_pk_add_f32 v[100:101], v[100:101], v[40:41]
    v_pk_add_f32 v[102:103], v[102:103], v[42:43]
    v_add_f32_dpp v84, v44, v84 row_shr:1 row_mask:0xf bank_mask:0xf bound_ctrl:1
    v_add_f32_dpp v85, v45, v85 row_shr:1 row_mask:0xf bank_mask:0xf bound_ctrl:1
    v_add_f32_dpp v86, v46, v86 row_shr:1 row_mask:0xf bank_mask:0xf bound_ctrl:1
    v_add_f32_dpp v87, v47, v87 row_shr:1 row_mask:0xf bank_mask:0xf bound_ctrl:1
    v_add_f32_dpp v108, v16, v108 row_shl:1 row_mask:0xf bank_mask:0xf bound_ctrl:1
    v_add_f32_dpp v109, v17, v109 row_shl:1 row_mask:0xf bank_mask:0xf bound_ctrl:1
    v_add_f32_dpp v110, v18, v110 row_shl:1 row_mask:0xf bank_mask:0xf bound_ctrl:1
    v_add_f32_dpp v111, v19, v111 row_shl:1 row_mask:0xf bank_mask:0xf bound_ctrl:1
    v_accvgpr_read_b32 v24, a200
    v_accvgpr_read_b32 v25, a201
    v_accvgpr_read_b32 v26, a202
    v_accvgpr_read_b32 v27, a203
    v_accvgpr_read_b32 v32, a208
    v_accvgpr_read_b32 v33, a209
    ds_write_b128 v166, v[92:95] offset:3072
    ds_write_b128 v166, v[100:103] offset:5120
    v_accvgpr_read_b32 v34, a210
    v_accvgpr_read_b32 v35, a211
    v_accvgpr_read_b32 v28, a204
    v_accvgpr_read_b32 v29, a205
    v_accvgpr_read_b32 v30, a206
    v_accvgpr_read_b32 v31, a207
    v_accvgpr_read_b32 v36, a212
    v_accvgpr_read_b32 v37, a213
    v_accvgpr_read_b32 v38, a214
    v_accvgpr_read_b32 v39, a215
    v_accvgpr_read_b32 v16, a192
    v_accvgpr_read_b32 v17, a193
    v_accvgpr_read_b32 v18, a194
    v_accvgpr_read_b32 v19, a195
    v_accvgpr_read_b32 v20, a196
    v_accvgpr_read_b32 v21, a197
    v_accvgpr_read_b32 v22, a198
    v_accvgpr_read_b32 v23, a199
    v_accvgpr_read_b32 v40, a216
    v_accvgpr_read_b32 v41, a217
    v_accvgpr_read_b32 v42, a218
    v_accvgpr_read_b32 v43, a219
    v_accvgpr_read_b32 v44, a220
    v_accvgpr_read_b32 v45, a221
    v_accvgpr_read_b32 v46, a222
    v_accvgpr_read_b32 v47, a223
    v_pk_add_f32 v[88:89], v[24:25], v[32:33]
    v_pk_add_f32 v[90:91], v[26:27], v[34:35]
    v_pk_add_f32 v[80:81], v[24:25], v[32:33] neg_lo:[0,1] neg_hi:[0,1]
    v_pk_add_f32 v[82:83], v[26:27], v[34:35] neg_lo:[0,1] neg_hi:[0,1]
    ds_write_b128 v166, v[84:87] offset:1024
    ds_write_b128 v166, v[108:111] offset:7168
    v_pk_add_f32 v[104:105], v[28:29], v[36:37]
    v_pk_add_f32 v[106:107], v[30:31], v[38:39]
    v_pk_add_f32 v[96:97], v[28:29], v[36:37] neg_lo:[0,1] neg_hi:[0,1]
    v_pk_add_f32 v[98:99], v[30:31], v[38:39] neg_lo:[0,1] neg_hi:[0,1]
    v_pk_add_f32 v[88:89], v[88:89], v[16:17] neg_lo:[0,1] neg_hi:[0,1]
    v_pk_add_f32 v[90:91], v[90:91], v[18:19] neg_lo:[0,1] neg_hi:[0,1]
    v_pk_add_f32 v[80:81], v[80:81], v[40:41] neg_lo:[0,1] neg_hi:[0,1]
    v_pk_add_f32 v[82:83], v[82:83], v[42:43] neg_lo:[0,1] neg_hi:[0,1]
    v_pk_add_f32 v[104:105], v[104:105], v[20:21] neg_lo:[0,1] neg_hi:[0,1]
    v_pk_add_f32 v[106:107], v[106:107], v[22:23] neg_lo:[0,1] neg_hi:[0,1]
    v_pk_add_f32 v[96:97], v[96:97], v[44:45] neg_lo:[0,1] neg_hi:[0,1]
    v_pk_add_f32 v[98:99], v[98:99], v[46:47] neg_lo:[0,1] neg_hi:[0,1]
    v_pk_add_f32 v[88:89], v[88:89], v[20:21]
    v_pk_add_f32 v[90:91], v[90:91], v[22:23]
    v_pk_add_f32 v[96:97], v[96:97], v[40:41]
    v_pk_add_f32 v[98:99], v[98:99], v[42:43]
    v_add_f32_dpp v80, v44, v80 row_shr:1 row_mask:0xf bank_mask:0xf bound_ctrl:1
    v_add_f32_dpp v81, v45, v81 row_shr:1 row_mask:0xf bank_mask:0xf bound_ctrl:1
    v_add_f32_dpp v82, v46, v82 row_shr:1 row_mask:0xf bank_mask:0xf bound_ctrl:1
    v_add_f32_dpp v83, v47, v83 row_shr:1 row_mask:0xf bank_mask:0xf bound_ctrl:1
    v_add_f32_dpp v104, v16, v104 row_shl:1 row_mask:0xf bank_mask:0xf bound_ctrl:1
    v_add_f32_dpp v105, v17, v105 row_shl:1 row_mask:0xf bank_mask:0xf bound_ctrl:1
    v_add_f32_dpp v106, v18, v106 row_shl:1 row_mask:0xf bank_mask:0xf bound_ctrl:1
    v_add_f32_dpp v107, v19, v107 row_shl:1 row_mask:0xf bank_mask:0xf bound_ctrl:1
    s_waitcnt vmcnt(6)
    s_nop 0
    v_pk_mul_f32 v[208:209], v[208:209], s[52:53] op_sel_hi:[1,0]
    v_pk_mul_f32 v[210:211], v[210:211], s[52:53] op_sel_hi:[1,0]
    v_pk_mul_f32 v[212:213], v[212:213], s[52:53] op_sel_hi:[1,0]
    v_pk_mul_f32 v[214:215], v[214:215], s[52:53] op_sel_hi:[1,0]
    v_add_f32_dpp v216, v216, v216 row_ror:8 row_mask:0xf bank_mask:0xf
    v_add_f32_dpp v217, v217, v217 row_ror:8 row_mask:0xf bank_mask:0xf
    v_add_f32_dpp v218, v218, v218 row_ror:8 row_mask:0xf bank_mask:0xf
    v_add_f32_dpp v219, v219, v219 row_ror:8 row_mask:0xf bank_mask:0xf
    v_add_f32_dpp v220, v220, v220 row_ror:8 row_mask:0xf bank_mask:0xf
    v_add_f32_dpp v221, v221, v221 row_ror:8 row_mask:0xf bank_mask:0xf
    v_add_f32_dpp v222, v222, v222 row_ror:8 row_mask:0xf bank_mask:0xf
    v_add_f32_dpp v223, v223, v223 row_ror:8 row_mask:0xf bank_mask:0xf
    v_add_f32_dpp v216, v216, v216 row_ror:4 row_mask:0xf bank_mask:0xf
    v_add_f32_dpp v217, v217, v217 row_ror:4 row_mask:0xf bank_mask:0xf
    v_add_f32_dpp v218, v218, v218 row_ror:4 row_mask:0xf bank_mask:0xf
    v_add_f32_dpp v219, v219, v219 row_ror:4 row_mask:0xf bank_mask:0xf
    v_add_f32_dpp v220, v220, v220 row_ror:4 row_mask:0xf bank_mask:0xf
    v_add_f32_dpp v221, v221, v221 row_ror:4 row_mask:0xf bank_mask:0xf
    v_add_f32_dpp v222, v222, v222 row_ror:4 row_mask:0xf bank_mask:0xf
    v_add_f32_dpp v223, v223, v223 row_ror:4 row_mask:0xf bank_mask:0xf
    v_add_f32_dpp v216, v216, v216 row_ror:2 row_mask:0xf bank_mask:0xf
    v_add_f32_dpp v217, v217, v217 row_ror:2 row_mask:0xf bank_mask:0xf
    v_add_f32_dpp v218, v218, v218 row_ror:2 row_mask:0xf bank_mask:0xf
    v_add_f32_dpp v219, v219, v219 row_ror:2 row_mask:0xf bank_mask:0xf
    v_add_f32_dpp v220, v220, v220 row_ror:2 row_mask:0xf bank_mask:0xf
    v_add_f32_dpp v221, v221, v221 row_ror:2 row_mask:0xf bank_mask:0xf
    v_add_f32_dpp v222, v222, v222 row_ror:2 row_mask:0xf bank_mask:0xf
    v_add_f32_dpp v223, v223, v223 row_ror:2 row_mask:0xf bank_mask:0xf
    v_add_f32_dpp v216, v216, v216 row_ror:1 row_mask:0xf bank_mask:0xf
    v_add_f32_dpp v217, v217, v217 row_ror:1 row_mask:0xf bank_mask:0xf
    v_add_f32_dpp v218, v218, v218 row_ror:1 row_mask:0xf bank_mask:0xf
    v_add_f32_dpp v219, v219, v219 row_ror:1 row_mask:0xf bank_mask:0xf
    v_add_f32_dpp v220, v220, v220 row_ror:1 row_mask:0xf bank_mask:0xf
    v_add_f32_dpp v221, v221, v221 row_ror:1 row_mask:0xf bank_mask:0xf
    v_add_f32_dpp v222, v222, v222 row_ror:1 row_mask:0xf bank_mask:0xf
    v_add_f32_dpp v223, v223, v223 row_ror:1 row_mask:0xf bank_mask:0xf
    s_waitcnt lgkmcnt(0)
    s_barrier
    ds_read_b128 v[112:115], v72 offset:0
    ds_read_b128 v[116:119], v72 offset:1024
    ds_read_b128 v[144:147], v72 offset:8192
    v_accvgpr_read_b32 v24, a232
    v_accvgpr_read_b32 v25, a233
    v_accvgpr_read_b32 v26, a234
    v_accvgpr_read_b32 v27, a235
    v_accvgpr_read_b32 v32, a240
    v_accvgpr_read_b32 v33, a241
    v_accvgpr_read_b32 v34, a242
    ds_read_b128 v[148:151], v72 offset:9216
    ds_read_b128 v[176:179], v72 offset:16384
    ds_read_b128 v[180:183], v72 offset:17408
    v_accvgpr_read_b32 v35, a243
    v_accvgpr_read_b32 v28, a236
    v_accvgpr_read_b32 v29, a237
    v_accvgpr_read_b32 v30, a238
    v_accvgpr_read_b32 v31, a239
    v_accvgpr_read_b32 v36, a244
    v_accvgpr_read_b32 v37, a245
    v_accvgpr_read_b32 v38, a246
    ds_read_b128 v[120:123], v72 offset:2048
    ds_read_b128 v[124:127], v72 offset:3072
    ds_read_b128 v[152:155], v72 offset:10240
    v_accvgpr_read_b32 v39, a247
    v_accvgpr_read_b32 v16, a224
    v_accvgpr_read_b32 v17, a225
    v_accvgpr_read_b32 v18, a226
    v_accvgpr_read_b32 v19, a227
    v_accvgpr_read_b32 v20, a228
    v_accvgpr_read_b32 v21, a229
    ds_read_b128 v[156:159], v72 offset:11264
    ds_read_b128 v[184:187], v72 offset:18432
    ds_read_b128 v[188:191], v72 offset:19456
    v_accvgpr_read_b32 v22, a230
    v_accvgpr_read_b32 v23, a231
    v_accvgpr_read_b32 v40, a248
    v_accvgpr_read_b32 v41, a249
    v_accvgpr_read_b32 v42, a250
    v_accvgpr_read_b32 v43, a251
    v_accvgpr_read_b32 v44, a252
    v_accvgpr_read_b32 v45, a253
    ds_read_b128 v[128:131], v72 offset:4096
    ds_read_b128 v[132:135], v72 offset:5120
    ds_read_b128 v[160:163], v72 offset:12288
    v_accvgpr_read_b32 v46, a254
    v_accvgpr_read_b32 v47, a255
    v_pk_add_f32 v[92:93], v[24:25], v[32:33]
    v_pk_add_f32 v[94:95], v[26:27], v[34:35]
    v_pk_add_f32 v[84:85], v[24:25], v[32:33] neg_lo:[0,1] neg_hi:[0,1]
    v_pk_add_f32 v[86:87], v[26:27], v[34:35] neg_lo:[0,1] neg_hi:[0,1]
    v_pk_add_f32 v[108:109], v[28:29], v[36:37]
    ds_read_b128 v[164:167], v72 offset:13312
    ds_read_b128 v[192:195], v72 offset:20480
    ds_read_b128 v[196:199], v72 offset:21504
    v_pk_add_f32 v[110:111], v[30:31], v[38:39]
    v_pk_add_f32 v[100:101], v[28:29], v[36:37] neg_lo:[0,1] neg_hi:[0,1]
    v_pk_add_f32 v[102:103], v[30:31], v[38:39] neg_lo:[0,1] neg_hi:[0,1]
    v_pk_add_f32 v[92:93], v[92:93], v[16:17] neg_lo:[0,1] neg_hi:[0,1]
    v_pk_add_f32 v[94:95], v[94:95], v[18:19] neg_lo:[0,1] neg_hi:[0,1]
    v_pk_add_f32 v[84:85], v[84:85], v[40:41] neg_lo:[0,1] neg_hi:[0,1]
    v_pk_add_f32 v[86:87], v[86:87], v[42:43] neg_lo:[0,1] neg_hi:[0,1]
    v_pk_add_f32 v[108:109], v[108:109], v[20:21] neg_lo:[0,1] neg_hi:[0,1]
    ds_read_b128 v[136:139], v72 offset:6144
    ds_read_b128 v[140:143], v72 offset:7168
    ds_read_b128 v[168:171], v72 offset:14336
    v_pk_add_f32 v[110:111], v[110:111], v[22:23] neg_lo:[0,1] neg_hi:[0,1]
    v_pk_add_f32 v[100:101], v[100:101], v[44:45] neg_lo:[0,1] neg_hi:[0,1]
    v_pk_add_f32 v[102:103], v[102:103], v[46:47] neg_lo:[0,1] neg_hi:[0,1]
    v_pk_add_f32 v[92:93], v[92:93], v[20:21]
    v_pk_add_f32 v[94:95], v[94:95], v[22:23]
    v_pk_add_f32 v[100:101], v[100:101], v[40:41]
    v_pk_add_f32 v[102:103], v[102:103], v[42:43]
    ds_read_b128 v[172:175], v72 offset:15360
    ds_read_b128 v[200:203], v72 offset:22528
    ds_read_b128 v[204:207], v72 offset:23552
    v_add_f32_dpp v84, v44, v84 row_shr:1 row_mask:0xf bank_mask:0xf bound_ctrl:1
    v_add_f32_dpp v85, v45, v85 row_shr:1 row_mask:0xf bank_mask:0xf bound_ctrl:1
    v_add_f32_dpp v86, v46, v86 row_shr:1 row_mask:0xf bank_mask:0xf bound_ctrl:1
    v_add_f32_dpp v87, v47, v87 row_shr:1 row_mask:0xf bank_mask:0xf bound_ctrl:1
    v_add_f32_dpp v108, v16, v108 row_shl:1 row_mask:0xf bank_mask:0xf bound_ctrl:1
    v_add_f32_dpp v109, v17, v109 row_shl:1 row_mask:0xf bank_mask:0xf bound_ctrl:1
    v_add_f32_dpp v110, v18, v110 row_shl:1 row_mask:0xf bank_mask:0xf bound_ctrl:1
    v_add_f32_dpp v111, v19, v111 row_shl:1 row_mask:0xf bank_mask:0xf bound_ctrl:1
    s_waitcnt lgkmcnt(15)
    s_nop 0
    v_pk_fma_f32 v[176:177], v[80:81], s[56:57], v[176:177] op_sel:[0,1,0]
    v_pk_fma_f32 v[178:179], v[82:83], s[56:57], v[178:179] op_sel:[0,1,0]
    v_pk_fma_f32 v[180:181], v[84:85], s[56:57], v[180:181] op_sel:[0,1,0]
    v_pk_fma_f32 v[182:183], v[86:87], s[56:57], v[182:183] op_sel:[0,1,0]
    v_pk_add_f32 v[80:81], v[80:81], v[112:113]
    v_pk_add_f32 v[82:83], v[82:83], v[114:115]
    v_pk_add_f32 v[84:85], v[84:85], v[116:117]
    v_pk_add_f32 v[86:87], v[86:87], v[118:119]
    v_pk_fma_f32 v[176:177], v[144:145], s[54:55], v[176:177] op_sel:[0,1,0]
    v_pk_fma_f32 v[178:179], v[146:147], s[54:55], v[178:179] op_sel:[0,1,0]
    v_pk_fma_f32 v[180:181], v[148:149], s[54:55], v[180:181] op_sel:[0,1,0]
    v_pk_fma_f32 v[182:183], v[150:151], s[54:55], v[182:183] op_sel:[0,1,0]
    v_pk_fma_f32 v[80:81], v[144:145], s[54:55], v[80:81] op_sel_hi:[1,0,1]
    v_pk_fma_f32 v[82:83], v[146:147], s[54:55], v[82:83] op_sel_hi:[1,0,1]
    v_pk_fma_f32 v[84:85], v[148:149], s[54:55], v[84:85] op_sel_hi:[1,0,1]
    v_pk_fma_f32 v[86:87], v[150:151], s[54:55], v[86:87] op_sel_hi:[1,0,1]
    v_pk_fma_f32 v[176:177], v[112:113], s[56:57], v[176:177] op_sel_hi:[1,0,1]
    v_pk_fma_f32 v[178:179], v[114:115], s[56:57], v[178:179] op_sel_hi:[1,0,1]
    v_pk_fma_f32 v[180:181], v[116:117], s[56:57], v[180:181] op_sel_hi:[1,0,1]
    v_pk_fma_f32 v[182:183], v[118:119], s[56:57], v[182:183] op_sel_hi:[1,0,1]
    s_waitcnt lgkmcnt(12)
    s_nop 0
    v_pk_fma_f32 v[184:185], v[88:89], s[56:57], v[184:185] op_sel:[0,1,0]
    v_pk_fma_f32 v[186:187], v[90:91], s[56:57], v[186:187] op_sel:[0,1,0]
    v_pk_fma_f32 v[188:189], v[92:93], s[56:57], v[188:189] op_sel:[0,1,0]
    v_pk_fma_f32 v[190:191], v[94:95], s[56:57], v[190:191] op_sel:[0,1,0]
    v_pk_add_f32 v[88:89], v[88:89], v[120:121]
    v_pk_add_f32 v[90:91], v[90:91], v[122:123]
    v_pk_add_f32 v[92:93], v[92:93], v[124:125]
    v_pk_add_f32 v[94:95], v[94:95], v[126:127]
    v_pk_fma_f32 v[184:185], v[152:153], s[54:55], v[184:185] op_sel:[0,1,0]
    v_pk_fma_f32 v[186:187], v[154:155], s[54:55], v[186:187] op_sel:[0,1,0]
    v_pk_fma_f32 v[188:189], v[156:157], s[54:55], v[188:189] op_sel:[0,1,0]
    v_pk_fma_f32 v[190:191], v[158:159], s[54:55], v[190:191] op_sel:[0,1,0]
    v_pk_fma_f32 v[88:89], v[152:153], s[54:55], v[88:89] op_sel_hi:[1,0,1]
    v_pk_fma_f32 v[90:91], v[154:155], s[54:55], v[90:91] op_sel_hi:[1,0,1]
    v_pk_fma_f32 v[92:93], v[156:157], s[54:55], v[92:93] op_sel_hi:[1,0,1]
    v_pk_fma_f32 v[94:95], v[158:159], s[54:55], v[94:95] op_sel_hi:[1,0,1]
    v_pk_fma_f32 v[184:185], v[120:121], s[56:57], v[184:185] op_sel_hi:[1,0,1]
    v_pk_fma_f32 v[186:187], v[122:123], s[56:57], v[186:187] op_sel_hi:[1,0,1]
    v_pk_fma_f32 v[188:189], v[124:125], s[56:57], v[188:189] op_sel_hi:[1,0,1]
    v_pk_fma_f32 v[190:191], v[126:127], s[56:57], v[190:191] op_sel_hi:[1,0,1]
    s_waitcnt lgkmcnt(6)
    s_nop 0
    v_pk_fma_f32 v[192:193], v[96:97], s[56:57], v[192:193] op_sel:[0,1,0]
    v_pk_fma_f32 v[194:195], v[98:99], s[56:57], v[194:195] op_sel:[0,1,0]
    v_pk_fma_f32 v[196:197], v[100:101], s[56:57], v[196:197] op_sel:[0,1,0]
    v_pk_fma_f32 v[198:199], v[102:103], s[56:57], v[198:199] op_sel:[0,1,0]
    v_pk_add_f32 v[96:97], v[96:97], v[128:129]
    v_pk_add_f32 v[98:99], v[98:99], v[130:131]
    v_pk_add_f32 v[100:101], v[100:101], v[132:133]
    v_pk_add_f32 v[102:103], v[102:103], v[134:135]
    v_pk_fma_f32 v[192:193], v[160:161], s[54:55], v[192:193] op_sel:[0,1,0]
    v_pk_fma_f32 v[194:195], v[162:163], s[54:55], v[194:195] op_sel:[0,1,0]
    v_pk_fma_f32 v[196:197], v[164:165], s[54:55], v[196:197] op_sel:[0,1,0]
    v_pk_fma_f32 v[198:199], v[166:167], s[54:55], v[198:199] op_sel:[0,1,0]
    v_pk_fma_f32 v[96:97], v[160:161], s[54:55], v[96:97] op_sel_hi:[1,0,1]
    v_pk_fma_f32 v[98:99], v[162:163], s[54:55], v[98:99] op_sel_hi:[1,0,1]
    v_pk_fma_f32 v[100:101], v[164:165], s[54:55], v[100:101] op_sel_hi:[1,0,1]
    v_pk_fma_f32 v[102:103], v[166:167], s[54:55], v[102:103] op_sel_hi:[1,0,1]
    v_pk_fma_f32 v[192:193], v[128:129], s[56:57], v[192:193] op_sel_hi:[1,0,1]
    v_pk_fma_f32 v[194:195], v[130:131], s[56:57], v[194:195] op_sel_hi:[1,0,1]
    v_pk_fma_f32 v[196:197], v[132:133], s[56:57], v[196:197] op_sel_hi:[1,0,1]
    v_pk_fma_f32 v[198:199], v[134:135], s[56:57], v[198:199] op_sel_hi:[1,0,1]
    s_waitcnt lgkmcnt(0)
    s_nop 0
    v_pk_fma_f32 v[200:201], v[104:105], s[56:57], v[200:201] op_sel:[0,1,0]
    v_pk_fma_f32 v[202:203], v[106:107], s[56:57], v[202:203] op_sel:[0,1,0]
    v_pk_fma_f32 v[204:205], v[108:109], s[56:57], v[204:205] op_sel:[0,1,0]
    v_pk_fma_f32 v[206:207], v[110:111], s[56:57], v[206:207] op_sel:[0,1,0]
    v_pk_add_f32 v[104:105], v[104:105], v[136:137]
    v_pk_add_f32 v[106:107], v[106:107], v[138:139]
    v_pk_add_f32 v[108:109], v[108:109], v[140:141]
    v_pk_add_f32 v[110:111], v[110:111], v[142:143]
    v_pk_fma_f32 v[200:201], v[168:169], s[54:55], v[200:201] op_sel:[0,1,0]
    v_pk_fma_f32 v[202:203], v[170:171], s[54:55], v[202:203] op_sel:[0,1,0]
    v_pk_fma_f32 v[204:205], v[172:173], s[54:55], v[204:205] op_sel:[0,1,0]
    v_pk_fma_f32 v[206:207], v[174:175], s[54:55], v[206:207] op_sel:[0,1,0]
    v_pk_fma_f32 v[104:105], v[168:169], s[54:55], v[104:105] op_sel_hi:[1,0,1]
    v_pk_fma_f32 v[106:107], v[170:171], s[54:55], v[106:107] op_sel_hi:[1,0,1]
    v_pk_fma_f32 v[108:109], v[172:173], s[54:55], v[108:109] op_sel_hi:[1,0,1]
    v_pk_fma_f32 v[110:111], v[174:175], s[54:55], v[110:111] op_sel_hi:[1,0,1]
    v_pk_fma_f32 v[200:201], v[136:137], s[56:57], v[200:201] op_sel_hi:[1,0,1]
    v_pk_fma_f32 v[202:203], v[138:139], s[56:57], v[202:203] op_sel_hi:[1,0,1]
    v_pk_fma_f32 v[204:205], v[140:141], s[56:57], v[204:205] op_sel_hi:[1,0,1]
    v_pk_fma_f32 v[206:207], v[142:143], s[56:57], v[206:207] op_sel_hi:[1,0,1]
    v_pk_fma_f32 v[80:81], v[80:81], v[208:209], v[216:217]
    v_pk_fma_f32 v[82:83], v[82:83], v[210:211], v[218:219]
    v_pk_fma_f32 v[84:85], v[84:85], v[212:213], v[220:221]
    v_pk_fma_f32 v[86:87], v[86:87], v[214:215], v[222:223]
    v_pk_fma_f32 v[176:177], v[176:177], v[208:209], v[216:217]
    v_pk_fma_f32 v[178:179], v[178:179], v[210:211], v[218:219]
    v_pk_fma_f32 v[180:181], v[180:181], v[212:213], v[220:221]
    v_pk_fma_f32 v[182:183], v[182:183], v[214:215], v[222:223]
    v_pk_mul_f32 v[68:69], v[80:81], v[80:81]
    v_pk_mul_f32 v[70:71], v[82:83], v[82:83]
    v_pk_add_f32 v[64:65], v[80:81], v[84:85]
    v_pk_add_f32 v[66:67], v[82:83], v[86:87]
    v_pk_fma_f32 v[68:69], v[84:85], v[84:85], v[68:69]
    v_pk_fma_f32 v[70:71], v[86:87], v[86:87], v[70:71]
    v_pk_add_f32 v[64:65], v[64:65], v[176:177]
    v_pk_fma_f32 v[68:69], v[176:177], v[176:177], v[68:69]
    v_pk_add_f32 v[66:67], v[66:67], v[178:179]
    v_pk_fma_f32 v[70:71], v[178:179], v[178:179], v[70:71]
    v_pk_add_f32 v[64:65], v[64:65], v[180:181]
    v_pk_fma_f32 v[68:69], v[180:181], v[180:181], v[68:69]
    v_pk_add_f32 v[66:67], v[66:67], v[182:183]
    v_pk_fma_f32 v[70:71], v[182:183], v[182:183], v[70:71]
    v_pk_fma_f32 v[88:89], v[88:89], v[208:209], v[216:217]
    v_pk_fma_f32 v[90:91], v[90:91], v[210:211], v[218:219]
    v_pk_fma_f32 v[92:93], v[92:93], v[212:213], v[220:221]
    v_pk_fma_f32 v[94:95], v[94:95], v[214:215], v[222:223]
    v_pk_fma_f32 v[184:185], v[184:185], v[208:209], v[216:217]
    v_pk_fma_f32 v[186:187], v[186:187], v[210:211], v[218:219]
    v_pk_fma_f32 v[188:189], v[188:189], v[212:213], v[220:221]
    v_pk_fma_f32 v[190:191], v[190:191], v[214:215], v[222:223]
    v_pk_add_f32 v[64:65], v[64:65], v[88:89]
    v_pk_fma_f32 v[68:69], v[88:89], v[88:89], v[68:69]
    v_pk_add_f32 v[66:67], v[66:67], v[90:91]
    v_pk_fma_f32 v[70:71], v[90:91], v[90:91], v[70:71]
    v_pk_add_f32 v[64:65], v[64:65], v[92:93]
    v_pk_fma_f32 v[68:69], v[92:93], v[92:93], v[68:69]
    v_pk_add_f32 v[66:67], v[66:67], v[94:95]
    v_pk_fma_f32 v[70:71], v[94:95], v[94:95], v[70:71]
    v_pk_add_f32 v[64:65], v[64:65], v[184:185]
    v_pk_fma_f32 v[68:69], v[184:185], v[184:185], v[68:69]
    v_pk_add_f32 v[66:67], v[66:67], v[186:187]
    v_pk_fma_f32 v[70:71], v[186:187], v[186:187], v[70:71]
    v_pk_add_f32 v[64:65], v[64:65], v[188:189]
    v_pk_fma_f32 v[68:69], v[188:189], v[188:189], v[68:69]
    v_pk_add_f32 v[66:67], v[66:67], v[190:191]
    v_pk_fma_f32 v[70:71], v[190:191], v[190:191], v[70:71]
    v_pk_fma_f32 v[96:97], v[96:97], v[208:209], v[216:217]
    v_pk_fma_f32 v[98:99], v[98:99], v[210:211], v[218:219]
    v_pk_fma_f32 v[100:101], v[100:101], v[212:213], v[220:221]
    v_pk_fma_f32 v[102:103], v[102:103], v[214:215], v[222:223]
    v_pk_fma_f32 v[192:193], v[192:193], v[208:209], v[216:217]
    v_pk_fma_f32 v[194:195], v[194:195], v[210:211], v[218:219]
    v_pk_fma_f32 v[196:197], v[196:197], v[212:213], v[220:221]
    v_pk_fma_f32 v[198:199], v[198:199], v[214:215], v[222:223]
    v_pk_add_f32 v[64:65], v[64:65], v[96:97]
    v_pk_fma_f32 v[68:69], v[96:97], v[96:97], v[68:69]
    v_pk_add_f32 v[66:67], v[66:67], v[98:99]
    v_pk_fma_f32 v[70:71], v[98:99], v[98:99], v[70:71]
    v_pk_add_f32 v[64:65], v[64:65], v[100:101]
    v_pk_fma_f32 v[68:69], v[100:101], v[100:101], v[68:69]
    v_pk_add_f32 v[66:67], v[66:67], v[102:103]
    v_pk_fma_f32 v[70:71], v[102:103], v[102:103], v[70:71]
    v_pk_add_f32 v[64:65], v[64:65], v[192:193]
    v_pk_fma_f32 v[68:69], v[192:193], v[192:193], v[68:69]
    v_pk_add_f32 v[66:67], v[66:67], v[194:195]
    v_pk_fma_f32 v[70:71], v[194:195], v[194:195], v[70:71]
    v_pk_add_f32 v[64:65], v[64:65], v[196:197]
    v_pk_fma_f32 v[68:69], v[196:197], v[196:197], v[68:69]
    v_pk_add_f32 v[66:67], v[66:67], v[198:199]
    v_pk_fma_f32 v[70:71], v[198:199], v[198:199], v[70:71]
    v_pk_fma_f32 v[104:105], v[104:105], v[208:209], v[216:217]
    v_pk_fma_f32 v[106:107], v[106:107], v[210:211], v[218:219]
    v_pk_fma_f32 v[108:109], v[108:109], v[212:213], v[220:221]
    v_pk_fma_f32 v[110:111], v[110:111], v[214:215], v[222:223]
    v_pk_fma_f32 v[200:201], v[200:201], v[208:209], v[216:217]
    v_pk_fma_f32 v[202:203], v[202:203], v[210:211], v[218:219]
    v_pk_fma_f32 v[204:205], v[204:205], v[212:213], v[220:221]
    v_pk_fma_f32 v[206:207], v[206:207], v[214:215], v[222:223]
    v_pk_add_f32 v[64:65], v[64:65], v[104:105]
    v_pk_fma_f32 v[68:69], v[104:105], v[104:105], v[68:69]
    v_pk_add_f32 v[66:67], v[66:67], v[106:107]
    v_pk_fma_f32 v[70:71], v[106:107], v[106:107], v[70:71]
    v_pk_add_f32 v[64:65], v[64:65], v[108:109]
    v_pk_fma_f32 v[68:69], v[108:109], v[108:109], v[68:69]
    v_pk_add_f32 v[66:67], v[66:67], v[110:111]
    v_pk_fma_f32 v[70:71], v[110:111], v[110:111], v[70:71]
    v_pk_add_f32 v[64:65], v[64:65], v[200:201]
    v_pk_fma_f32 v[68:69], v[200:201], v[200:201], v[68:69]
    v_pk_add_f32 v[66:67], v[66:67], v[202:203]
    v_pk_fma_f32 v[70:71], v[202:203], v[202:203], v[70:71]
    v_pk_add_f32 v[64:65], v[64:65], v[204:205]
    v_pk_fma_f32 v[68:69], v[204:205], v[204:205], v[68:69]
    v_pk_add_f32 v[66:67], v[66:67], v[206:207]
    v_pk_fma_f32 v[70:71], v[206:207], v[206:207], v[70:71]
    v_mov_b32 v52, 1
    s_waitcnt vmcnt(0)
    s_mov_b64 exec, 1
    buffer_store_dword v52, v9, s[16:19], s73 offen sc1
    s_mov_b64 exec, -1
    v_pk_add_f32 v[64:65], v[64:65], v[66:67]
    v_pk_add_f32 v[68:69], v[68:69], v[70:71]
    v_add_f32 v64, v64, v65
    v_add_f32 v65, v68, v69
    v_mov_b32_e64 v60, 0
    v_add_f32_dpp v64, v64, v64 row_shr:1 row_mask:0xf bank_mask:0xf bound_ctrl:1
    v_add_f32_dpp v65, v65, v65 row_shr:1 row_mask:0xf bank_mask:0xf bound_ctrl:1
    v_mov_b32_e64 v61, 0
    v_add_f32_dpp v64, v64, v64 row_shr:2 row_mask:0xf bank_mask:0xf bound_ctrl:1
    v_add_f32_dpp v65, v65, v65 row_shr:2 row_mask:0xf bank_mask:0xf bound_ctrl:1
    v_add_u32 v40, 160080, v9
    v_add_f32_dpp v64, v64, v64 row_shr:4 row_mask:0xf bank_mask:0xf bound_ctrl:1
    v_add_f32_dpp v65, v65, v65 row_shr:4 row_mask:0xf bank_mask:0xf bound_ctrl:1
    v_lshrrev_b32_e64 v41, 1, v12
    v_add_f32_dpp v64, v64, v64 row_shr:8 row_mask:0xf bank_mask:0xf bound_ctrl:1
    v_add_f32_dpp v65, v65, v65 row_shr:8 row_mask:0xf bank_mask:0xf bound_ctrl:1
    v_add_u32 v41, 160080, v41
    v_add_f32_dpp v64, v64, v64 row_bcast:15 row_mask:0xa bank_mask:0xf
    v_add_f32_dpp v65, v65, v65 row_bcast:15 row_mask:0xa bank_mask:0xf
    v_mov_b32 v24, 0x44354000
    v_add_f32_dpp v64, v64, v64 row_bcast:31 row_mask:0xc bank_mask:0xf
    v_add_f32_dpp v65, v65, v65 row_bcast:31 row_mask:0xc bank_mask:0xf
    s_lshl_b64 exec, 1, 63
    v_or_b32 v65, 0x80000000, v65
    buffer_store_dwordx2 v[64:65], v9, s[16:19], s96 offen
    buffer_store_dwordx2 v[64:65], v9, s[16:19], s97 offen sc1
    s_mov_b64 exec, -1
    ds_read_b128 v[16:19], v40
    ds_read_b128 v[20:23], v40 offset:1024
    ds_read_b128 v[28:31], v41
    ds_read_b128 v[32:35], v41 offset:1024
    v_mov_b32 v62, 0
    v_mov_b32 v63, 0
    s_mul_i32 s40, s35, 98304
    s_lshl_b32 s41, s35, 19
    s_mov_b32 s85, s87
    s_mov_b32 s44, 0
    s_mov_b32 s84, 4
    s_mov_b32 s74, 32768
    s_mov_b32 s23, 0
    s_add_u32 s80, s80, L_epi1-L_tail
L_pad2:
    s_cbranch_execz L_padC
    s_nop 0
    s_addc_u32 s81, s81, 0
    s_add_u32 s4, s4, 0x700000
    s_addc_u32 s5, s5, 0
    s_add_u32 s8, s8, 0x900000
    s_addc_u32 s9, s9, 0
    s_add_u32 s12, s12, 0x900000
    s_addc_u32 s13, s13, 0
    v_bfe_u32 v55, v9, 4, 2
    v_min_u32 v55, 2, v55
    s_add_i32 s37, s36, -1
    v_add_u32 v55, s37, v55
    v_med3_i32 v55, v55, 0, 15
    s_lshl_b32 s37, s31, 6
    v_xor_b32 v56, s37, v9
    v_and_b32_e64 v56, 64, v56
    v_lshl_add_u32 v55, v55, 7, v56
    s_lshl_b32 s37, s32, 11
    s_add_u32 s37, s37, 196640
    v_add_u32 v55, s37, v55
    v_add_u32 v53, s83, v9
    v_add_u32 v54, s69, v9
    s_waitcnt lgkmcnt(0)
    s_nop 0
    v_and_b32 v16, 0x7fff7fff, v16
    v_and_b32 v17, 0x7fff7fff, v17
    v_and_b32 v18, 0x7fff7fff, v18
    v_and_b32 v19, 0x7fff7fff, v19
    v_pk_max_u16 v16, v16, v17
    v_pk_max_u16 v18, v18, v19
    v_pk_max_u16 v16, v16, v18
    v_lshlrev_b32 v17, 16, v16
    v_and_b32 v18, s88, v16
    v_max_u32_e64 v16, v17, v18
    v_and_b32 v20, 0x7fff7fff, v20
    v_and_b32 v21, 0x7fff7fff, v21
    v_and_b32 v22, 0x7fff7fff, v22
    v_and_b32 v23, 0x7fff7fff, v23
    v_pk_max_u16 v20, v20, v21
    v_pk_max_u16 v22, v22, v23
    v_pk_max_u16 v20, v20, v22
    v_lshlrev_b32 v21, 16, v20
    v_and_b32 v22, s88, v20
    v_max_u32_e64 v20, v21, v22
    v_fma_f32 v24, v16, v24, v20
    v_lshlrev_b32 v208, 16, v28
    v_and_b32 v209, s88, v28
    v_lshlrev_b32_e64 v216, 16, v32
    v_max_u32_dpp v24, v24, v24 row_shr:1 row_mask:0xf bank_mask:0xf bound_ctrl:1
    v_and_b32 v217, s88, v32
    v_lshlrev_b32 v210, 16, v29
    v_and_b32_e64 v211, s88, v29
    v_max_u32_dpp v24, v24, v24 row_shr:2 row_mask:0xf bank_mask:0xf bound_ctrl:1
    v_lshlrev_b32_e64 v218, 16, v33
    buffer_load_dwordx4 v[72:75], v13, s[16:19], 0 offen sc1
    v_and_b32_e64 v219, s88, v33
    v_max_u32_dpp v24, v24, v24 row_shr:4 row_mask:0xf bank_mask:0xf bound_ctrl:1
    v_lshlrev_b32 v212, 16, v30
    v_and_b32 v213, s88, v30
    v_lshlrev_b32_e64 v220, 16, v34
    v_max_u32_dpp v24, v24, v24 row_shr:8 row_mask:0xf bank_mask:0xf bound_ctrl:1
    v_and_b32 v221, s88, v34
    v_lshlrev_b32 v214, 16, v31
    v_and_b32_e64 v215, s88, v31
    v_max_u32_dpp v24, v24, v24 row_bcast:15 row_mask:0xa bank_mask:0xf
    v_lshlrev_b32 v222, 16, v35
    v_and_b32 v223, s88, v35
    v_max_u32_dpp v24, v24, v24 row_bcast:31 row_mask:0xc bank_mask:0xf
    s_mov_b32 s38, 0xbfb8aa3b
    v_frexp_exp_i32_f32_e64 v24, v24
    v_pk_mul_f32 v[208:209], v[208:209], s[38:39] op_sel_hi:[1,0]
    v_readlane_b32 s52, v24, 63
    v_pk_mul_f32 v[210:211], v[210:211], s[38:39] op_sel_hi:[1,0]
    v_pk_mul_f32 v[212:213], v[212:213], s[38:39] op_sel_hi:[1,0]
    v_pk_mul_f32 v[214:215], v[214:215], s[38:39] op_sel_hi:[1,0]
    v_pk_mul_f32 v[216:217], v[216:217], s[38:39] op_sel_hi:[1,0]
    v_pk_mul_f32 v[218:219], v[218:219], s[38:39] op_sel_hi:[1,0]
    v_pk_mul_f32 v[220:221], v[220:221], s[38:39] op_sel_hi:[1,0]
    v_pk_mul_f32 v[222:223], v[222:223], s[38:39] op_sel_hi:[1,0]
    s_max_i32 s52, s52, -100
    s_min_i32 s52, s52, 120
    s_add_i32 s52, s52, 114
    s_lshl_b32 s52, s52, 23
    s_or_b32 s53, s52, 0x8038aa3b
    s_waitcnt vmcnt(0)
    v_and_b32 v76, v73, v75
    v_cmp_le_i32 vcc, 0, v76
    s_nop 0
    s_cmp_lg_u64 vcc, 0
    s_cbranch_scc1 L_pstat1_slow
L_pstat1_out:
    v_add_f32 v72, v72, v74
    v_add_f32 v73, abs(v73), abs(v75)
    s_nop 0
    v_add_f32_dpp v72, v72, v72 row_shr:1 row_mask:0xf bank_mask:0xf bound_ctrl:1
    v_add_f32_dpp v73, v73, v73 row_shr:1 row_mask:0xf bank_mask:0xf bound_ctrl:1
    s_nop 0
    v_add_f32_dpp v72, v72, v72 row_shr:2 row_mask:0xf bank_mask:0xf bound_ctrl:1
    v_add_f32_dpp v73, v73, v73 row_shr:2 row_mask:0xf bank_mask:0xf bound_ctrl:1
    s_nop 0
    v_add_f32_dpp v72, v72, v72 row_shr:4 row_mask:0xf bank_mask:0xf bound_ctrl:1
    v_add_f32_dpp v73, v73, v73 row_shr:4 row_mask:0xf bank_mask:0xf bound_ctrl:1
    s_nop 0
    v_add_f32_dpp v72, v72, v72 row_shr:8 row_mask:0xf bank_mask:0xf bound_ctrl:1
    v_add_f32_dpp v73, v73, v73 row_shr:8 row_mask:0xf bank_mask:0xf bound_ctrl:1
    s_nop 0
    v_add_f32_dpp v72, v72, v72 row_bcast:15 row_mask:0xa bank_mask:0xf
    v_add_f32_dpp v73, v73, v73 row_bcast:15 row_mask:0xa bank_mask:0xf
    s_nop 0
    v_add_f32_dpp v72, v72, v72 row_bcast:31 row_mask:0xc bank_mask:0xf
    v_add_f32_dpp v73, v73, v73 row_bcast:31 row_mask:0xc bank_mask:0xf
    v_mul_f32 v72, 0x36000000, v72
    v_mul_f32 v73, 0x36000000, v73
    v_fma_f32 v73, -v72, v72, v73
    v_max_f32_e64 v73, 0, v73
    v_add_f32 v73, 0x3727c5ac, v73
    v_rsq_f32_e64 v73, v73
    v_readlane_b32 s38, v72, 63
    v_readlane_b32 s39, v73, 63
    s_nop 1
    s_nop 0
    v_pk_mul_f32 v[208:209], v[208:209], s[38:39] op_sel:[0,1]
    v_pk_mul_f32 v[210:211], v[210:211], s[38:39] op_sel:[0,1]
    v_pk_mul_f32 v[212:213], v[212:213], s[38:39] op_sel:[0,1]
    v_pk_mul_f32 v[214:215], v[214:215], s[38:39] op_sel:[0,1]
    v_pk_fma_f32 v[216:217], v[208:209], s[38:39], v[216:217] op_sel_hi:[1,0,1] neg_lo:[1,0,0] neg_hi:[1,0,0]
    v_pk_fma_f32 v[218:219], v[210:211], s[38:39], v[218:219] op_sel_hi:[1,0,1] neg_lo:[1,0,0] neg_hi:[1,0,0]
    v_pk_fma_f32 v[220:221], v[212:213], s[38:39], v[220:221] op_sel_hi:[1,0,1] neg_lo:[1,0,0] neg_hi:[1,0,0]
    v_pk_fma_f32 v[222:223], v[214:215], s[38:39], v[222:223] op_sel_hi:[1,0,1] neg_lo:[1,0,0] neg_hi:[1,0,0]
    v_pk_fma_f32 v[80:81], v[80:81], v[208:209], v[216:217]
    v_pk_fma_f32 v[82:83], v[82:83], v[210:211], v[218:219]
    v_pk_fma_f32 v[84:85], v[84:85], v[212:213], v[220:221]
    v_pk_fma_f32 v[86:87], v[86:87], v[214:215], v[222:223]
    v_exp_f32 v64, v80
    v_exp_f32 v65, v81
    v_exp_f32 v66, v82
    v_exp_f32 v67, v83
    v_exp_f32 v68, v84
    v_exp_f32 v69, v85
    v_exp_f32 v70, v86
    v_exp_f32 v71, v87
    v_pk_fma_f32 v[64:65], v[64:65], s[52:53], s[52:53] op_sel:[0,1,1]
    v_pk_fma_f32 v[66:67], v[66:67], s[52:53], s[52:53] op_sel:[0,1,1]
    v_pk_fma_f32 v[68:69], v[68:69], s[52:53], s[52:53] op_sel:[0,1,1]
    v_pk_fma_f32 v[70:71], v[70:71], s[52:53], s[52:53] op_sel:[0,1,1]
    v_rcp_f32 v64, v64
    v_rcp_f32 v65, v65
    v_rcp_f32 v66, v66
    v_rcp_f32 v67, v67
    v_rcp_f32 v68, v68
    v_rcp_f32 v69, v69
    v_rcp_f32 v70, v70
    v_rcp_f32 v71, v71
    v_pk_mul_f32 v[80:81], v[80:81], v[64:65]
    v_pk_mul_f32 v[82:83], v[82:83], v[66:67]
    v_pk_mul_f32 v[84:85], v[84:85], v[68:69]
    v_pk_mul_f32 v[86:87], v[86:87], v[70:71]
    v_cvt_pk_f16_f32 v80, v80, v81
    v_cvt_pk_f16_f32 v81, v82, v83
    v_cvt_pk_f16_f32 v82, v84, v85
    v_cvt_pk_f16_f32 v83, v86, v87
    buffer_store_dwordx4 v[80:83], v9, s[12:15], s29 offen offset:0 sc1
    v_pk_fma_f32 v[88:89], v[88:89], v[208:209], v[216:217]
    v_pk_fma_f32 v[90:91], v[90:91], v[210:211], v[218:219]
    v_pk_fma_f32 v[92:93], v[92:93], v[212:213], v[220:221]
    v_pk_fma_f32 v[94:95], v[94:95], v[214:215], v[222:223]
    v_exp_f32 v64, v88
    v_exp_f32 v65, v89
    v_exp_f32 v66, v90
    v_exp_f32 v67, v91
    v_exp_f32 v68, v92
    v_exp_f32 v69, v93
    v_exp_f32 v70, v94
    v_exp_f32 v71, v95
    v_pk_fma_f32 v[64:65], v[64:65], s[52:53], s[52:53] op_sel:[0,1,1]
    v_pk_fma_f32 v[66:67], v[66:67], s[52:53], s[52:53] op_sel:[0,1,1]
    v_pk_fma_f32 v[68:69], v[68:69], s[52:53], s[52:53] op_sel:[0,1,1]
    v_pk_fma_f32 v[70:71], v[70:71], s[52:53], s[52:53] op_sel:[0,1,1]
    v_rcp_f32 v64, v64
    v_rcp_f32 v65, v65
    v_rcp_f32 v66, v66
    v_rcp_f32 v67, v67
    v_rcp_f32 v68, v68
    v_rcp_f32 v69, v69
    v_rcp_f32 v70, v70
    v_rcp_f32 v71, v71
    v_pk_mul_f32 v[88:89], v[88:89], v[64:65]
    v_pk_mul_f32 v[90:91], v[90:91], v[66:67]
    v_pk_mul_f32 v[92:93], v[92:93], v[68:69]
    v_pk_mul_f32 v[94:95], v[94:95], v[70:71]
    v_cvt_pk_f16_f32 v88, v88, v89
    v_cvt_pk_f16_f32 v89, v90, v91
    v_cvt_pk_f16_f32 v90, v92, v93
    v_cvt_pk_f16_f32 v91, v94, v95
    buffer_store_dwordx4 v[88:91], v9, s[12:15], s29 offen offset:1024 sc1
    v_pk_fma_f32 v[96:97], v[96:97], v[208:209], v[216:217]
    v_pk_fma_f32 v[98:99], v[98:99], v[210:211], v[218:219]
    v_pk_fma_f32 v[100:101], v[100:101], v[212:213], v[220:221]
    v_pk_fma_f32 v[102:103], v[102:103], v[214:215], v[222:223]
    v_exp_f32 v64, v96
    v_exp_f32 v65, v97
    v_exp_f32 v66, v98
    v_exp_f32 v67, v99
    v_exp_f32 v68, v100
    v_exp_f32 v69, v101
    v_exp_f32 v70, v102
    v_exp_f32 v71, v103
    v_pk_fma_f32 v[64:65], v[64:65], s[52:53], s[52:53] op_sel:[0,1,1]
    v_pk_fma_f32 v[66:67], v[66:67], s[52:53], s[52:53] op_sel:[0,1,1]
    v_pk_fma_f32 v[68:69], v[68:69], s[52:53], s[52:53] op_sel:[0,1,1]
    v_pk_fma_f32 v[70:71], v[70:71], s[52:53], s[52:53] op_sel:[0,1,1]
    v_rcp_f32 v64, v64
    v_rcp_f32 v65, v65
    v_rcp_f32 v66, v66
    v_rcp_f32 v67, v67
    v_rcp_f32 v68, v68
    v_rcp_f32 v69, v69
    v_rcp_f32 v70, v70
    v_rcp_f32 v71, v71
    v_pk_mul_f32 v[96:97], v[96:97], v[64:65]
    v_pk_mul_f32 v[98:99], v[98:99], v[66:67]
    v_pk_mul_f32 v[100:101], v[100:101], v[68:69]
    v_pk_mul_f32 v[102:103], v[102:103], v[70:71]
    v_cvt_pk_f16_f32 v96, v96, v97
    v_cvt_pk_f16_f32 v97, v98, v99
    v_cvt_pk_f16_f32 v98, v100, v101
    v_cvt_pk_f16_f32 v99, v102, v103
    buffer_store_dwordx4 v[96:99], v9, s[12:15], s29 offen offset:2048 sc1
    v_pk_fma_f32 v[104:105], v[104:105], v[208:209], v[216:217]
    v_pk_fma_f32 v[106:107], v[106:107], v[210:211], v[218:219]
    v_pk_fma_f32 v[108:109], v[108:109], v[212:213], v[220:221]
    v_pk_fma_f32 v[110:111], v[110:111], v[214:215], v[222:223]
    v_exp_f32 v64, v104
    v_exp_f32 v65, v105
    v_exp_f32 v66, v106
    v_exp_f32 v67, v107
    v_exp_f32 v68, v108
    v_exp_f32 v69, v109
    v_exp_f32 v70, v110
    v_exp_f32 v71, v111
    v_pk_fma_f32 v[64:65], v[64:65], s[52:53], s[52:53] op_sel:[0,1,1]
    v_pk_fma_f32 v[66:67], v[66:67], s[52:53], s[52:53] op_sel:[0,1,1]
    v_pk_fma_f32 v[68:69], v[68:69], s[52:53], s[52:53] op_sel:[0,1,1]
    v_pk_fma_f32 v[70:71], v[70:71], s[52:53], s[52:53] op_sel:[0,1,1]
    v_rcp_f32 v64, v64
    v_rcp_f32 v65, v65
    v_rcp_f32 v66, v66
    v_rcp_f32 v67, v67
    v_rcp_f32 v68, v68
    v_rcp_f32 v69, v69
    v_rcp_f32 v70, v70
    v_rcp_f32 v71, v71
    v_pk_mul_f32 v[104:105], v[104:105], v[64:65]
    v_pk_mul_f32 v[106:107], v[106:107], v[66:67]
    v_pk_mul_f32 v[108:109], v[108:109], v[68:69]
    v_pk_mul_f32 v[110:111], v[110:111], v[70:71]
    v_cvt_pk_f16_f32 v104, v104, v105
    v_cvt_pk_f16_f32 v105, v106, v107
    v_cvt_pk_f16_f32 v106, v108, v109
    v_cvt_pk_f16_f32 v107, v110, v111
    buffer_store_dwordx4 v[104:107], v9, s[12:15], s29 offen offset:3072 sc1
    s_mov_b32 exec_hi, 0
    buffer_load_dwordx4 v[48:51], v11, s[16:19], s74 offen offset:16 sc1
    s_mov_b64 exec, -1
    v_pk_fma_f32 v[176:177], v[176:177], v[208:209], v[216:217]
    v_pk_fma_f32 v[178:179], v[178:179], v[210:211], v[218:219]
    v_pk_fma_f32 v[180:181], v[180:181], v[212:213], v[220:221]
    v_pk_fma_f32 v[182:183], v[182:183], v[214:215], v[222:223]
    v_exp_f32 v64, v176
    v_exp_f32 v65, v177
    v_exp_f32 v66, v178
    v_exp_f32 v67, v179
    v_exp_f32 v68, v180
    v_exp_f32 v69, v181
    v_exp_f32 v70, v182
    v_exp_f32 v71, v183
    v_pk_fma_f32 v[64:65], v[64:65], s[52:53], s[52:53] op_sel:[0,1,1]
    v_pk_fma_f32 v[66:67], v[66:67], s[52:53], s[52:53] op_sel:[0,1,1]
    v_pk_fma_f32 v[68:69], v[68:69], s[52:53], s[52:53] op_sel:[0,1,1]
    v_pk_fma_f32 v[70:71], v[70:71], s[52:53], s[52:53] op_sel:[0,1,1]
    v_rcp_f32 v64, v64
    v_rcp_f32 v65, v65
    v_rcp_f32 v66, v66
    v_rcp_f32 v67, v67
    v_rcp_f32 v68, v68
    v_rcp_f32 v69, v69
    v_rcp_f32 v70, v70
    v_rcp_f32 v71, v71
    v_pk_mul_f32 v[176:177], v[176:177], v[64:65]
    v_pk_mul_f32 v[178:179], v[178:179], v[66:67]
    v_pk_mul_f32 v[180:181], v[180:181], v[68:69]
    v_pk_mul_f32 v[182:183], v[182:183], v[70:71]
    v_cvt_pk_f16_f32 v176, v176, v177
    v_cvt_pk_f16_f32 v177, v178, v179
    v_cvt_pk_f16_f32 v178, v180, v181
    v_cvt_pk_f16_f32 v179, v182, v183
    buffer_store_dwordx4 v[176:179], v9, s[12:15], s30 offen offset:0 sc1
    v_pk_fma_f32 v[184:185], v[184:185], v[208:209], v[216:217]
    v_pk_fma_f32 v[186:187], v[186:187], v[210:211], v[218:219]
    v_pk_fma_f32 v[188:189], v[188:189], v[212:213], v[220:221]
    v_pk_fma_f32 v[190:191], v[190:191], v[214:215], v[222:223]
    v_exp_f32 v64, v184
    v_exp_f32 v65, v185
    v_exp_f32 v66, v186
    v_exp_f32 v67, v187
    v_exp_f32 v68, v188
    v_exp_f32 v69, v189
    v_exp_f32 v70, v190
    v_exp_f32 v71, v191
    v_pk_fma_f32 v[64:65], v[64:65], s[52:53], s[52:53] op_sel:[0,1,1]
    v_pk_fma_f32 v[66:67], v[66:67], s[52:53], s[52:53] op_sel:[0,1,1]
    v_pk_fma_f32 v[68:69], v[68:69], s[52:53], s[52:53] op_sel:[0,1,1]
    v_pk_fma_f32 v[70:71], v[70:71], s[52:53], s[52:53] op_sel:[0,1,1]
    v_rcp_f32 v64, v64
    v_rcp_f32 v65, v65
    v_rcp_f32 v66, v66
    v_rcp_f32 v67, v67
    v_rcp_f32 v68, v68
    v_rcp_f32 v69, v69
    v_rcp_f32 v70, v70
    v_rcp_f32 v71, v71
    v_pk_mul_f32 v[184:185], v[184:185], v[64:65]
    v_pk_mul_f32 v[186:187], v[186:187], v[66:67]
    v_pk_mul_f32 v[188:189], v[188:189], v[68:69]
    v_pk_mul_f32 v[190:191], v[190:191], v[70:71]
    v_cvt_pk_f16_f32 v184, v184, v185
    v_cvt_pk_f16_f32 v185, v186, v187
    v_cvt_pk_f16_f32 v186, v188, v189
    v_cvt_pk_f16_f32 v187, v190, v191
    buffer_store_dwordx4 v[184:187], v9, s[12:15], s30 offen offset:1024 sc1
    v_pk_fma_f32 v[192:193], v[192:193], v[208:209], v[216:217]
    v_pk_fma_f32 v[194:195], v[194:195], v[210:211], v[218:219]
    v_pk_fma_f32 v[196:197], v[196:197], v[212:213], v[220:221]
    v_pk_fma_f32 v[198:199], v[198:199], v[214:215], v[222:223]
    v_exp_f32 v64, v192
    v_exp_f32 v65, v193
    v_exp_f32 v66, v194
    v_exp_f32 v67, v195
    v_exp_f32 v68, v196
    v_exp_f32 v69, v197
    v_exp_f32 v70, v198
    v_exp_f32 v71, v199
    v_pk_fma_f32 v[64:65], v[64:65], s[52:53], s[52:53] op_sel:[0,1,1]
    v_pk_fma_f32 v[66:67], v[66:67], s[52:53], s[52:53] op_sel:[0,1,1]
    v_pk_fma_f32 v[68:69], v[68:69], s[52:53], s[52:53] op_sel:[0,1,1]
    v_pk_fma_f32 v[70:71], v[70:71], s[52:53], s[52:53] op_sel:[0,1,1]
    v_rcp_f32 v64, v64
    v_rcp_f32 v65, v65
    v_rcp_f32 v66, v66
    v_rcp_f32 v67, v67
    v_rcp_f32 v68, v68
    v_rcp_f32 v69, v69
    v_rcp_f32 v70, v70
    v_rcp_f32 v71, v71
    v_pk_mul_f32 v[192:193], v[192:193], v[64:65]
    v_pk_mul_f32 v[194:195], v[194:195], v[66:67]
    v_pk_mul_f32 v[196:197], v[196:197], v[68:69]
    v_pk_mul_f32 v[198:199], v[198:199], v[70:71]
    v_cvt_pk_f16_f32 v192, v192, v193
    v_cvt_pk_f16_f32 v193, v194, v195
    v_cvt_pk_f16_f32 v194, v196, v197
    v_cvt_pk_f16_f32 v195, v198, v199
    buffer_store_dwordx4 v[192:195], v9, s[12:15], s30 offen offset:2048 sc1
    v_pk_fma_f32 v[200:201], v[200:201], v[208:209], v[216:217]
    v_pk_fma_f32 v[202:203], v[202:203], v[210:211], v[218:219]
    v_pk_fma_f32 v[204:205], v[204:205], v[212:213], v[220:221]
    v_pk_fma_f32 v[206:207], v[206:207], v[214:215], v[222:223]
    v_exp_f32 v64, v200
    v_exp_f32 v65, v201
    v_exp_f32 v66, v202
    v_exp_f32 v67, v203
    v_exp_f32 v68, v204
    v_exp_f32 v69, v205
    v_exp_f32 v70, v206
    v_exp_f32 v71, v207
    v_pk_fma_f32 v[64:65], v[64:65], s[52:53], s[52:53] op_sel:[0,1,1]
    v_pk_fma_f32 v[66:67], v[66:67], s[52:53], s[52:53] op_sel:[0,1,1]
    v_pk_fma_f32 v[68:69], v[68:69], s[52:53], s[52:53] op_sel:[0,1,1]
    v_pk_fma_f32 v[70:71], v[70:71], s[52:53], s[52:53] op_sel:[0,1,1]
    v_rcp_f32 v64, v64
    v_rcp_f32 v65, v65
    v_rcp_f32 v66, v66
    v_rcp_f32 v67, v67
    v_rcp_f32 v68, v68
    v_rcp_f32 v69, v69
    v_rcp_f32 v70, v70
    v_rcp_f32 v71, v71
    v_pk_mul_f32 v[200:201], v[200:201], v[64:65]
    v_pk_mul_f32 v[202:203], v[202:203], v[66:67]
    v_pk_mul_f32 v[204:205], v[204:205], v[68:69]
    v_pk_mul_f32 v[206:207], v[206:207], v[70:71]
    v_cvt_pk_f16_f32 v200, v200, v201
    v_cvt_pk_f16_f32 v201, v202, v203
    v_cvt_pk_f16_f32 v202, v204, v205
    v_cvt_pk_f16_f32 v203, v206, v207
    buffer_store_dwordx4 v[200:203], v9, s[12:15], s30 offen offset:3072 sc1
    v_add_u32 v78, s78, v9
    v_add_u32 v79, s79, v9
    s_waitcnt vmcnt(4)
    v_mov_b32 v76, 1
    s_mov_b64 exec, 1
    buffer_store_dword v76, v9, s[16:19], s20 offen
    buffer_store_dword v76, v9, s[16:19], s21 offen sc1
    s_mov_b64 exec, -1
    s_lshr_b64 s[0:1], -1, 32
    v_min3_u32 v48, v48, v49, v50
    v_min_u32 v48, v48, v51
    v_cmp_gt_u32 vcc, 1, v48
    s_nop 0
    s_and_b64 vcc, vcc, s[0:1]
    s_cbranch_scc1 L_pollu_slow
L_pollu_out:
    ds_write_b128 v78, v[80:83] offset:0
    buffer_load_dwordx4 v[128:131], v1, s[4:7], s40 offen offset:0 sc1
    v_mfma_f32_32x32x16_f16 a[0:15], v[60:63], v[60:63], 0
    ds_write_b128 v78, v[88:91] offset:1024
    buffer_load_dwordx4 v[132:135], v1, s[4:7], s40 offen offset:1024 sc1
    v_mfma_f32_32x32x16_f16 a[16:31], v[60:63], v[60:63], 0
    ds_write_b128 v78, v[96:99] offset:2048
    buffer_load_dwordx4 v[136:139], v1, s[4:7], s40 offen offset:2048 sc1
    v_mfma_f32_32x32x16_f16 a[32:47], v[60:63], v[60:63], 0
    ds_write_b128 v78, v[104:107] offset:3072
    s_add_u32 s40, s40, 12288
    v_mfma_f32_32x32x16_f16 a[48:63], v[60:63], v[60:63], 0
    ds_write_b128 v79, v[176:179] offset:0
    buffer_load_dwordx4 v[140:143], v1, s[4:7], s40 offen offset:0 sc1
    v_mfma_f32_32x32x16_f16 a[64:79], v[60:63], v[60:63], 0
    ds_write_b128 v79, v[184:187] offset:1024
    buffer_load_dwordx4 v[144:147], v1, s[4:7], s40 offen offset:1024 sc1
    v_mfma_f32_32x32x16_f16 a[80:95], v[60:63], v[60:63], 0
    ds_write_b128 v79, v[192:195] offset:2048
    buffer_load_dwordx4 v[148:151], v1, s[4:7], s40 offen offset:2048 sc1
    v_mfma_f32_32x32x16_f16 a[96:111], v[60:63], v[60:63], 0
    ds_write_b128 v79, v[200:203] offset:3072
    s_add_u32 s40, s40, 12288
    v_mfma_f32_32x32x16_f16 a[112:127], v[60:63], v[60:63], 0
    s_waitcnt lgkmcnt(0)
    s_barrier
    ds_read_b128 v[80:83], v5 offset:24576
    ds_read_b128 v[88:91], v7 offset:24576
    ds_read_b128 v[84:87], v5 offset:25600
    ds_read_b128 v[92:95], v7 offset:25600
    ds_read_b128 v[96:99], v5 offset:26624
    ds_read_b128 v[104:107], v7 offset:26624
    ds_read_b128 v[100:103], v5 offset:27648
    ds_read_b128 v[108:111], v7 offset:27648
    s_mov_b64 exec, 15
    buffer_load_dwordx4 v[72:75], v55, s[16:19], 0 offen sc1
    s_mov_b64 exec, -1
    s_waitcnt lgkmcnt(4)
    s_nop 0
    v_pk_fma_f16 v16, v88, s42, v80
    v_pk_fma_f16 v17, v89, s42, v81
    v_pk_fma_f16 v18, v90, s42, v82
    v_pk_fma_f16 v19, v91, s42, v83
    buffer_load_dwordx4 v[152:155], v1, s[4:7], s40 offen offset:0 sc1
    v_mfma_f32_32x32x16_f16 a[128:143], v[60:63], v[60:63], 0
    v_pk_fma_f16 v28, v92, s42, v84
    v_pk_fma_f16 v29, v93, s42, v85
    v_pk_fma_f16 v30, v94, s42, v86
    v_pk_fma_f16 v31, v95, s42, v87
    buffer_load_dwordx4 v[156:159], v1, s[4:7], s40 offen offset:1024 sc1
    v_mfma_f32_32x32x16_f16 a[144:159], v[60:63], v[60:63], 0
    v_pk_add_f16 v20, v16, v28
    v_pk_add_f16 v21, v17, v29
    v_pk_add_f16 v22, v18, v30
    v_pk_add_f16 v23, v19, v31
    buffer_load_dwordx4 v[160:163], v1, s[4:7], s40 offen offset:2048 sc1
    v_mfma_f32_32x32x16_f16 a[160:175], v[60:63], v[60:63], 0
    v_pk_add_f16 v24, v16, v28 neg_lo:[0,1] neg_hi:[0,1]
    v_pk_add_f16 v25, v17, v29 neg_lo:[0,1] neg_hi:[0,1]
    v_pk_add_f16 v26, v18, v30 neg_lo:[0,1] neg_hi:[0,1]
    v_pk_add_f16 v27, v19, v31 neg_lo:[0,1] neg_hi:[0,1]
    s_add_u32 s40, s40, 12288
    v_mfma_f32_32x32x16_f16 a[176:191], v[60:63], v[60:63], 0
    s_waitcnt lgkmcnt(0)
    s_nop 0
    v_pk_fma_f16 v32, v104, s42, v96
    v_pk_fma_f16 v33, v105, s42, v97
    v_pk_fma_f16 v34, v106, s42, v98
    v_pk_fma_f16 v35, v107, s42, v99
    buffer_load_dwordx4 v[164:167], v1, s[4:7], s40 offen offset:0 sc1
    v_mfma_f32_32x32x16_f16 a[192:207], v[60:63], v[60:63], 0
    v_pk_fma_f16 v44, v108, s42, v100
    v_pk_fma_f16 v45, v109, s42, v101
    v_pk_fma_f16 v46, v110, s42, v102
    v_pk_fma_f16 v47, v111, s42, v103
    buffer_load_dwordx4 v[168:171], v1, s[4:7], s40 offen offset:1024 sc1
    v_mfma_f32_32x32x16_f16 a[208:223], v[60:63], v[60:63], 0
    v_pk_add_f16 v36, v32, v44
    v_pk_add_f16 v37, v33, v45
    v_pk_add_f16 v38, v34, v46
    v_pk_add_f16 v39, v35, v47
    buffer_load_dwordx4 v[172:175], v1, s[4:7], s40 offen offset:2048 sc1
    v_mfma_f32_32x32x16_f16 a[224:239], v[60:63], v[60:63], 0
    v_pk_add_f16 v40, v32, v44 neg_lo:[0,1] neg_hi:[0,1]
    v_pk_add_f16 v41, v33, v45 neg_lo:[0,1] neg_hi:[0,1]
    v_pk_add_f16 v42, v34, v46 neg_lo:[0,1] neg_hi:[0,1]
    v_pk_add_f16 v43, v35, v47 neg_lo:[0,1] neg_hi:[0,1]
    s_add_u32 s40, s40, 12288
    v_mfma_f32_32x32x16_f16 a[240:255], v[60:63], v[60:63], 0
    s_waitcnt vmcnt(6)
    v_mov_b32 v76, 2
    s_mov_b64 exec, 1
    buffer_store_dword v76, v9, s[16:19], s20 offen
    buffer_store_dword v76, v9, s[16:19], s21 offen sc1
    s_mov_b64 exec, -1
    v_min3_u32 v72, v72, v73, v74
    v_min_u32 v72, v72, v75
    v_cmp_gt_u32 vcc, 1, v72
    s_nop 0
    s_and_b64 vcc, vcc, 15
    s_cbranch_scc1 L_polle1_slow
L_polle1_out:
    s_and_b32 s86, s85, 15
    s_add_u32 m0, s70, 24576
    s_nop 0
    buffer_load_dwordx4 v53, s[8:11], s41 offen sc1 lds
    s_add_u32 m0, s70, 45056
    s_nop 0
    buffer_load_dwordx4 v54, s[8:11], s41 offen sc1 lds
    s_add_u32 m0, s70, 0
    s_add_u32 s41, s41, 0x40000
    buffer_load_dwordx4 v53, s[8:11], s41 offen sc1 lds
    s_add_u32 m0, s70, 20480
    s_nop 0
    buffer_load_dwordx4 v54, s[8:11], s41 offen sc1 lds
    s_lshl_b32 s41, s86, 19
    s_mov_b64 exec, 0xf0
    buffer_load_dwordx4 v[68:71], v55, s[16:19], 0 offen sc1
    s_mov_b64 exec, -1
    buffer_load_dwordx4 v[176:179], v1, s[4:7], s40 offen offset:0 sc1
    buffer_load_dwordx4 v[180:183], v1, s[4:7], s40 offen offset:1024 sc1
    buffer_load_dwordx4 v[184:187], v1, s[4:7], s40 offen offset:2048 sc1
    s_add_u32 s40, s40, 12288
    buffer_load_dwordx4 v[188:191], v1, s[4:7], s40 offen offset:0 sc1
    buffer_load_dwordx4 v[192:195], v1, s[4:7], s40 offen offset:1024 sc1
    buffer_load_dwordx4 v[196:199], v1, s[4:7], s40 offen offset:2048 sc1
    s_waitcnt vmcnt(17)
    s_nop 0
    v_pk_add_f16 v112, v132, v136
    v_pk_add_f16 v113, v133, v137
    v_pk_add_f16 v114, v134, v138
    v_pk_add_f16 v115, v135, v139
    v_pk_add_f16 v136, v128, v136
    v_pk_add_f16 v137, v129, v137
    v_pk_add_f16 v138, v130, v138
    v_pk_add_f16 v139, v131, v139
    v_pk_add_f16 v116, v144, v148
    v_pk_add_f16 v117, v145, v149
    v_pk_add_f16 v118, v146, v150
    s_waitcnt vmcnt(9)
    s_barrier
    ds_read_b128 v[80:83], v6 offset:24576
    ds_read_b128 v[88:91], v8 offset:24576
    ds_read_b128 v[84:87], v6 offset:25600
    ds_read_b128 v[92:95], v8 offset:25600
    ds_read_b128 v[96:99], v6 offset:26624
    ds_read_b128 v[104:107], v8 offset:26624
    ds_read_b128 v[100:103], v6 offset:27648
    ds_read_b128 v[108:111], v8 offset:27648
    s_mov_b32 s47, 4
    s_mov_b32 s72, s45
    s_waitcnt vmcnt(6)
    v_mov_b32 v76, 4
    s_mov_b64 exec, 1
    buffer_store_dword v76, v9, s[16:19], s71 offen offset:8 sc1
    s_mov_b64 exec, -1
    v_min3_u32 v68, v68, v69, v70
    v_min_u32 v68, v68, v71
    v_cmp_gt_u32 vcc, 2, v68
    s_nop 0
    s_and_b64 vcc, vcc, 0xf0
    s_cbranch_scc1 L_polla1_slow
L_polla1_out:
    s_branch L_loop
    s_nop 0
L_pollu_slow:
    s_mov_b32 s37, 262144
    s_mov_b64 exec, s[0:1]
L_pollu:
    buffer_load_dwordx4 v[48:51], v11, s[16:19], s74 offen offset:16 sc1
    s_sub_u32 s37, s37, 1
    s_cbranch_scc1 L_pollu_end
    s_waitcnt vmcnt(0)
    v_min3_u32 v48, v48, v49, v50
    v_min_u32 v48, v48, v51
    v_cmp_gt_u32 vcc, 1, v48
    s_nop 0
    s_and_b64 vcc, vcc, s[0:1]
    s_cbranch_scc1 L_pollu
L_pollu_end:
    s_mov_b64 exec, -1
    s_branch L_pollu_out
    s_nop 0
L_polla1_slow:
    s_mov_b32 s37, 262144
    s_mov_b64 exec, 0xf0
L_polla1:
    buffer_load_dwordx4 v[68:71], v55, s[16:19], 0 offen sc1
    s_sub_u32 s37, s37, 1
    s_cbranch_scc1 L_polla1_end
    s_waitcnt vmcnt(0)
    v_min3_u32 v68, v68, v69, v70
    v_min_u32 v68, v68, v71
    v_cmp_gt_u32 vcc, 2, v68
    s_nop 0
    s_and_b64 vcc, vcc, 0xf0
    s_cbranch_scc1 L_polla1
L_polla1_end:
    s_mov_b64 exec, -1
    s_branch L_polla1_out
.p2alignl 12, 0xbf810000
L_padB:
    s_branch L_back
    s_nop 0
L_pstat1_slow:
    s_mov_b32 s37, 262144
    s_mov_b64 exec, -1
L_pstat1:
    buffer_load_dwordx4 v[72:75], v13, s[16:19], 0 offen sc1
    s_sub_u32 s37, s37, 1
    s_cbranch_scc1 L_pstat1_end
    s_waitcnt vmcnt(0)
    v_and_b32 v76, v73, v75
    v_cmp_le_i32 vcc, 0, v76
    s_nop 0
    s_cmp_lg_u64 vcc, 0
    s_cbranch_scc1 L_pstat1
L_pstat1_end:
    s_mov_b64 exec, -1
    s_branch L_pstat1_out
    s_nop 0
L_polle1_slow:
    s_mov_b32 s37, 262144
    s_mov_b64 exec, 15
L_polle1:
    buffer_load_dwordx4 v[72:75], v55, s[16:19], 0 offen sc1
    s_sub_u32 s37, s37, 1
    s_cbranch_scc1 L_polle1_end
    s_waitcnt vmcnt(0)
    v_min3_u32 v72, v72, v73, v74
    v_min_u32 v72, v72, v75
    v_cmp_gt_u32 vcc, 1, v72
    s_nop 0
    s_and_b64 vcc, vcc, 15
    s_cbranch_scc1 L_polle1
L_polle1_end:
    s_mov_b64 exec, -1
    s_branch L_polle1_out
    s_nop 0
L_epi1:
    v_mfma_f32_16x16x32_f16 a[128:131], v[200:203], v[16:19], a[128:131]
    v_add_u32 v167, s28, v9
    v_add_u32 v164, s25, v9
    v_mfma_f32_16x16x32_f16 a[160:163], v[212:215], v[16:19], a[160:163]
    v_add_u32 v165, s26, v9
    v_add_u32 v166, s27, v9
    v_mfma_f32_16x16x32_f16 a[136:139], v[204:207], v[20:23], a[136:139]
    v_xor_b32 v11, 128, v10
    v_accvgpr_read_b32 v143, a15
    v_mfma_f32_16x16x32_f16 a[168:171], v[216:219], v[20:23], a[168:171]
    s_mov_b64 s[12:13], s[90:91]
    v_accvgpr_read_b32 v148, a20
    v_accvgpr_read_b32 v149, a21
    v_mfma_f32_16x16x32_f16 a[152:155], v[120:123], v[28:31], a[152:155]
    v_accvgpr_read_b32 v150, a22
    v_accvgpr_read_b32 v151, a23
    v_mfma_f32_16x16x32_f16 a[184:187], v[124:127], v[28:31], a[184:187]
    v_accvgpr_read_b32 v128, a0
    v_accvgpr_read_b32 v129, a1
    v_mfma_f32_16x16x32_f16 a[144:147], v[208:211], v[24:27], a[144:147]
    v_accvgpr_read_b32 v130, a2
    v_accvgpr_read_b32 v131, a3
    v_mfma_f32_16x16x32_f16 a[176:179], v[220:223], v[24:27], a[176:179]
    v_accvgpr_read_b32 v132, a4
    v_accvgpr_read_b32 v133, a5
    v_mfma_f32_16x16x32_f16 a[132:135], v[200:203], v[32:35], a[132:135]
    v_accvgpr_read_b32 v134, a6
    v_accvgpr_read_b32 v135, a7
    v_mfma_f32_16x16x32_f16 a[164:167], v[212:215], v[32:35], a[164:167]
    v_accvgpr_read_b32 v152, a24
    v_accvgpr_read_b32 v153, a25
    v_mfma_f32_16x16x32_f16 a[156:159], v[120:123], v[44:47], a[156:159]
    v_accvgpr_read_b32 v154, a26
    v_accvgpr_read_b32 v155, a27
    v_mfma_f32_16x16x32_f16 a[188:191], v[124:127], v[44:47], a[188:191]
    v_accvgpr_read_b32 v156, a28
    v_accvgpr_read_b32 v157, a29
    v_mfma_f32_16x16x32_f16 a[140:143], v[204:207], v[36:39], a[140:143]
    v_accvgpr_read_b32 v158, a30
    v_accvgpr_read_b32 v159, a31
    v_mfma_f32_16x16x32_f16 a[172:175], v[216:219], v[36:39], a[172:175]
    v_accvgpr_read_b32 v24, a72
    v_accvgpr_read_b32 v25, a73
    v_mfma_f32_16x16x32_f16 a[148:151], v[208:211], v[40:43], a[148:151]
    v_accvgpr_read_b32 v26, a74
    v_accvgpr_read_b32 v27, a75
    v_mfma_f32_16x16x32_f16 a[180:183], v[220:223], v[40:43], a[180:183]
    v_accvgpr_read_b32 v32, a80
    v_accvgpr_read_b32 v33, a81
    v_mfma_f32_16x16x32_f16 a[192:195], v[200:203], v[48:51], a[192:195]
    v_accvgpr_read_b32 v34, a82
    v_accvgpr_read_b32 v35, a83
    v_mfma_f32_16x16x32_f16 a[224:227], v[212:215], v[48:51], a[224:227]
    v_accvgpr_read_b32 v28, a76
    v_accvgpr_read_b32 v29, a77
    v_mfma_f32_16x16x32_f16 a[216:219], v[120:123], v[60:63], a[216:219]
    v_accvgpr_read_b32 v30, a78
    v_accvgpr_read_b32 v31, a79
    v_mfma_f32_16x16x32_f16 a[248:251], v[124:127], v[60:63], a[248:251]
    v_accvgpr_read_b32 v36, a84
    v_accvgpr_read_b32 v37, a85
    v_mfma_f32_16x16x32_f16 a[200:203], v[204:207], v[52:55], a[200:203]
    v_accvgpr_read_b32 v38, a86
    v_accvgpr_read_b32 v39, a87
    v_mfma_f32_16x16x32_f16 a[232:235], v[216:219], v[52:55], a[232:235]
    v_accvgpr_read_b32 v16, a64
    v_accvgpr_read_b32 v17, a65
    v_mfma_f32_16x16x32_f16 a[208:211], v[208:211], v[56:59], a[208:211]
    v_accvgpr_read_b32 v18, a66
    v_accvgpr_read_b32 v19, a67
    v_mfma_f32_16x16x32_f16 a[240:243], v[220:223], v[56:59], a[240:243]
    v_accvgpr_read_b32 v20, a68
    v_accvgpr_read_b32 v21, a69
    v_mfma_f32_16x16x32_f16 a[196:199], v[200:203], v[64:67], a[196:199]
    v_accvgpr_read_b32 v22, a70
    v_accvgpr_read_b32 v23, a71
    v_mfma_f32_16x16x32_f16 a[228:231], v[212:215], v[64:67], a[228:231]
    v_accvgpr_read_b32 v40, a88
    v_accvgpr_read_b32 v41, a89
    v_mfma_f32_16x16x32_f16 a[220:223], v[120:123], v[76:79], a[220:223]
    v_accvgpr_read_b32 v42, a90
    v_accvgpr_read_b32 v43, a91
    v_mfma_f32_16x16x32_f16 a[252:255], v[124:127], v[76:79], a[252:255]
    v_accvgpr_read_b32 v44, a92
    v_accvgpr_read_b32 v45, a93
    v_mfma_f32_16x16x32_f16 a[204:207], v[204:207], v[68:71], a[204:207]
    v_accvgpr_read_b32 v46, a94
    v_accvgpr_read_b32 v47, a95
    v_mfma_f32_16x16x32_f16 a[236:239], v[216:219], v[68:71], a[236:239]
    v_accvgpr_read_b32 v184, a136
    v_accvgpr_read_b32 v185, a137
    v_mfma_f32_16x16x32_f16 a[212:215], v[208:211], v[72:75], a[212:215]
    v_accvgpr_read_b32 v186, a138
    v_accvgpr_read_b32 v187, a139
    v_mfma_f32_16x16x32_f16 a[244:247], v[220:223], v[72:75], a[244:247]
    v_accvgpr_read_b32 v192, a144
    v_accvgpr_read_b32 v193, a145
L_mfma_done1:
    s_nop 0
    buffer_load_dwordx4 v[208:211], v12, s[16:19], 0 offen offset:2048 sc1
    buffer_load_dwordx4 v[212:215], v12, s[16:19], 0 offen offset:2064 sc1
    v_pk_add_f32 v[92:93], v[136:137], v[144:145]
    v_pk_add_f32 v[94:95], v[138:139], v[146:147]
    v_pk_add_f32 v[84:85], v[136:137], v[144:145] neg_lo:[0,1] neg_hi:[0,1]
    v_pk_add_f32 v[86:87], v[138:139], v[146:147] neg_lo:[0,1] neg_hi:[0,1]
    v_pk_add_f32 v[108:109], v[140:141], v[148:149]
    v_pk_add_f32 v[110:111], v[142:143], v[150:151]
    v_pk_add_f32 v[100:101], v[140:141], v[148:149] neg_lo:[0,1] neg_hi:[0,1]
    v_pk_add_f32 v[102:103], v[142:143], v[150:151] neg_lo:[0,1] neg_hi:[0,1]
    v_pk_add_f32 v[92:93], v[92:93], v[128:129] neg_lo:[0,1] neg_hi:[0,1]
    v_pk_add_f32 v[94:95], v[94:95], v[130:131] neg_lo:[0,1] neg_hi:[0,1]
    v_pk_add_f32 v[84:85], v[84:85], v[152:153] neg_lo:[0,1] neg_hi:[0,1]
    v_pk_add_f32 v[86:87], v[86:87], v[154:155] neg_lo:[0,1] neg_hi:[0,1]
    v_pk_add_f32 v[108:109], v[108:109], v[132:133] neg_lo:[0,1] neg_hi:[0,1]
    v_pk_add_f32 v[110:111], v[110:111], v[134:135] neg_lo:[0,1] neg_hi:[0,1]
    v_pk_add_f32 v[100:101], v[100:101], v[156:157] neg_lo:[0,1] neg_hi:[0,1]
    v_pk_add_f32 v[102:103], v[102:103], v[158:159] neg_lo:[0,1] neg_hi:[0,1]
    v_pk_add_f32 v[92:93], v[92:93], v[132:133]
    v_pk_add_f32 v[94:95], v[94:95], v[134:135]
    v_pk_add_f32 v[100:101], v[100:101], v[152:153]
    v_pk_add_f32 v[102:103], v[102:103], v[154:155]
    v_add_f32_dpp v84, v156, v84 row_shr:1 row_mask:0xf bank_mask:0xf bound_ctrl:1
    v_add_f32_dpp v85, v157, v85 row_shr:1 row_mask:0xf bank_mask:0xf bound_ctrl:1
    v_add_f32_dpp v86, v158, v86 row_shr:1 row_mask:0xf bank_mask:0xf bound_ctrl:1
    v_add_f32_dpp v87, v159, v87 row_shr:1 row_mask:0xf bank_mask:0xf bound_ctrl:1
    v_add_f32_dpp v108, v128, v108 row_shl:1 row_mask:0xf bank_mask:0xf bound_ctrl:1
    v_add_f32_dpp v109, v129, v109 row_shl:1 row_mask:0xf bank_mask:0xf bound_ctrl:1
    v_add_f32_dpp v110, v130, v110 row_shl:1 row_mask:0xf bank_mask:0xf bound_ctrl:1
    v_add_f32_dpp v111, v131, v111 row_shl:1 row_mask:0xf bank_mask:0xf bound_ctrl:1
    v_pk_add_f32 v[52:53], v[24:25], v[32:33]
    v_pk_add_f32 v[54:55], v[26:27], v[34:35]
    v_pk_add_f32 v[48:49], v[24:25], v[32:33] neg_lo:[0,1] neg_hi:[0,1]
    v_pk_add_f32 v[50:51], v[26:27], v[34:35] neg_lo:[0,1] neg_hi:[0,1]
    v_pk_add_f32 v[60:61], v[28:29], v[36:37]
    v_pk_add_f32 v[62:63], v[30:31], v[38:39]
    v_pk_add_f32 v[56:57], v[28:29], v[36:37] neg_lo:[0,1] neg_hi:[0,1]
    v_pk_add_f32 v[58:59], v[30:31], v[38:39] neg_lo:[0,1] neg_hi:[0,1]
    v_pk_add_f32 v[52:53], v[52:53], v[16:17] neg_lo:[0,1] neg_hi:[0,1]
    v_pk_add_f32 v[54:55], v[54:55], v[18:19] neg_lo:[0,1] neg_hi:[0,1]
    v_pk_add_f32 v[48:49], v[48:49], v[40:41] neg_lo:[0,1] neg_hi:[0,1]
    v_pk_add_f32 v[50:51], v[50:51], v[42:43] neg_lo:[0,1] neg_hi:[0,1]
    v_pk_add_f32 v[60:61], v[60:61], v[20:21] neg_lo:[0,1] neg_hi:[0,1]
    v_pk_add_f32 v[62:63], v[62:63], v[22:23] neg_lo:[0,1] neg_hi:[0,1]
    ds_write_b128 v164, v[92:95] offset:2048
    v_pk_add_f32 v[56:57], v[56:57], v[44:45] neg_lo:[0,1] neg_hi:[0,1]
    v_pk_add_f32 v[58:59], v[58:59], v[46:47] neg_lo:[0,1] neg_hi:[0,1]
    v_pk_add_f32 v[52:53], v[52:53], v[20:21]
    v_pk_add_f32 v[54:55], v[54:55], v[22:23]
    v_pk_add_f32 v[56:57], v[56:57], v[40:41]
    v_pk_add_f32 v[58:59], v[58:59], v[42:43]
    v_add_f32_dpp v48, v44, v48 row_shr:1 row_mask:0xf bank_mask:0xf bound_ctrl:1
    v_add_f32_dpp v49, v45, v49 row_shr:1 row_mask:0xf bank_mask:0xf bound_ctrl:1
    v_add_f32_dpp v50, v46, v50 row_shr:1 row_mask:0xf bank_mask:0xf bound_ctrl:1
    v_add_f32_dpp v51, v47, v51 row_shr:1 row_mask:0xf bank_mask:0xf bound_ctrl:1
    v_add_f32_dpp v60, v16, v60 row_shl:1 row_mask:0xf bank_mask:0xf bound_ctrl:1
    v_add_f32_dpp v61, v17, v61 row_shl:1 row_mask:0xf bank_mask:0xf bound_ctrl:1
    v_add_f32_dpp v62, v18, v62 row_shl:1 row_mask:0xf bank_mask:0xf bound_ctrl:1
    v_add_f32_dpp v63, v19, v63 row_shl:1 row_mask:0xf bank_mask:0xf bound_ctrl:1
    ds_write_b128 v164, v[100:103] offset:4096
    v_accvgpr_read_b32 v194, a146
    v_accvgpr_read_b32 v195, a147
    v_accvgpr_read_b32 v188, a140
    v_accvgpr_read_b32 v189, a141
    v_accvgpr_read_b32 v190, a142
    v_accvgpr_read_b32 v191, a143
    v_accvgpr_read_b32 v196, a148
    v_accvgpr_read_b32 v197, a149
    v_accvgpr_read_b32 v198, a150
    ds_write_b128 v164, v[84:87] offset:0
    v_accvgpr_read_b32 v199, a151
    v_accvgpr_read_b32 v176, a128
    v_accvgpr_read_b32 v177, a129
    v_accvgpr_read_b32 v178, a130
    v_accvgpr_read_b32 v179, a131
    v_accvgpr_read_b32 v180, a132
    v_accvgpr_read_b32 v181, a133
    v_accvgpr_read_b32 v182, a134
    v_accvgpr_read_b32 v183, a135
    ds_write_b128 v164, v[108:111] offset:6144
    v_accvgpr_read_b32 v112, a152
    v_accvgpr_read_b32 v113, a153
    v_accvgpr_read_b32 v114, a154
    v_accvgpr_read_b32 v115, a155
    v_accvgpr_read_b32 v116, a156
    v_accvgpr_read_b32 v117, a157
    v_accvgpr_read_b32 v118, a158
    v_accvgpr_read_b32 v119, a159
    v_pk_add_f32 v[68:69], v[184:185], v[192:193]
    ds_write_b128 v165, v[52:55] offset:2048
    v_pk_add_f32 v[70:71], v[186:187], v[194:195]
    v_pk_add_f32 v[64:65], v[184:185], v[192:193] neg_lo:[0,1] neg_hi:[0,1]
    v_pk_add_f32 v[66:67], v[186:187], v[194:195] neg_lo:[0,1] neg_hi:[0,1]
    v_pk_add_f32 v[76:77], v[188:189], v[196:197]
    v_pk_add_f32 v[78:79], v[190:191], v[198:199]
    v_pk_add_f32 v[72:73], v[188:189], v[196:197] neg_lo:[0,1] neg_hi:[0,1]
    v_pk_add_f32 v[74:75], v[190:191], v[198:199] neg_lo:[0,1] neg_hi:[0,1]
    v_pk_add_f32 v[68:69], v[68:69], v[176:177] neg_lo:[0,1] neg_hi:[0,1]
    v_pk_add_f32 v[70:71], v[70:71], v[178:179] neg_lo:[0,1] neg_hi:[0,1]
    ds_write_b128 v165, v[56:59] offset:4096
    v_pk_add_f32 v[64:65], v[64:65], v[112:113] neg_lo:[0,1] neg_hi:[0,1]
    v_pk_add_f32 v[66:67], v[66:67], v[114:115] neg_lo:[0,1] neg_hi:[0,1]
    v_pk_add_f32 v[76:77], v[76:77], v[180:181] neg_lo:[0,1] neg_hi:[0,1]
    v_pk_add_f32 v[78:79], v[78:79], v[182:183] neg_lo:[0,1] neg_hi:[0,1]
    v_pk_add_f32 v[72:73], v[72:73], v[116:117] neg_lo:[0,1] neg_hi:[0,1]
    v_pk_add_f32 v[74:75], v[74:75], v[118:119] neg_lo:[0,1] neg_hi:[0,1]
    v_pk_add_f32 v[68:69], v[68:69], v[180:181]
    v_pk_add_f32 v[70:71], v[70:71], v[182:183]
    v_pk_add_f32 v[72:73], v[72:73], v[112:113]
    ds_write_b128 v165, v[48:51] offset:0
    v_pk_add_f32 v[74:75], v[74:75], v[114:115]
    v_add_f32_dpp v64, v116, v64 row_shr:1 row_mask:0xf bank_mask:0xf bound_ctrl:1
    v_add_f32_dpp v65, v117, v65 row_shr:1 row_mask:0xf bank_mask:0xf bound_ctrl:1
    v_add_f32_dpp v66, v118, v66 row_shr:1 row_mask:0xf bank_mask:0xf bound_ctrl:1
    v_add_f32_dpp v67, v119, v67 row_shr:1 row_mask:0xf bank_mask:0xf bound_ctrl:1
    v_add_f32_dpp v76, v176, v76 row_shl:1 row_mask:0xf bank_mask:0xf bound_ctrl:1
    v_add_f32_dpp v77, v177, v77 row_shl:1 row_mask:0xf bank_mask:0xf bound_ctrl:1
    v_add_f32_dpp v78, v178, v78 row_shl:1 row_mask:0xf bank_mask:0xf bound_ctrl:1
    v_add_f32_dpp v79, v179, v79 row_shl:1 row_mask:0xf bank_mask:0xf bound_ctrl:1
    ds_write_b128 v165, v[60:63] offset:6144
    v_accvgpr_read_b32 v24, a200
    v_accvgpr_read_b32 v25, a201
    v_accvgpr_read_b32 v26, a202
    v_accvgpr_read_b32 v27, a203
    v_accvgpr_read_b32 v32, a208
    v_accvgpr_read_b32 v33, a209
    v_accvgpr_read_b32 v34, a210
    v_accvgpr_read_b32 v35, a211
    v_accvgpr_read_b32 v28, a204
    v_accvgpr_read_b32 v29, a205
    ds_write_b128 v166, v[68:71] offset:2048
    v_accvgpr_read_b32 v30, a206
    v_accvgpr_read_b32 v31, a207
    v_accvgpr_read_b32 v36, a212
    v_accvgpr_read_b32 v37, a213
    v_accvgpr_read_b32 v38, a214
    v_accvgpr_read_b32 v39, a215
    v_accvgpr_read_b32 v16, a192
    v_accvgpr_read_b32 v17, a193
    v_accvgpr_read_b32 v18, a194
    v_accvgpr_read_b32 v19, a195
    ds_write_b128 v166, v[72:75] offset:4096
    v_accvgpr_read_b32 v20, a196
    v_accvgpr_read_b32 v21, a197
    v_accvgpr_read_b32 v22, a198
    v_accvgpr_read_b32 v23, a199
    v_accvgpr_read_b32 v40, a216
    v_accvgpr_read_b32 v41, a217
    v_accvgpr_read_b32 v42, a218
    v_accvgpr_read_b32 v43, a219
    v_accvgpr_read_b32 v44, a220
    v_accvgpr_read_b32 v45, a221
    ds_write_b128 v166, v[64:67] offset:0
    v_accvgpr_read_b32 v46, a222
    v_accvgpr_read_b32 v47, a223
    v_pk_add_f32 v[88:89], v[24:25], v[32:33]
    v_pk_add_f32 v[90:91], v[26:27], v[34:35]
    v_pk_add_f32 v[80:81], v[24:25], v[32:33] neg_lo:[0,1] neg_hi:[0,1]
    v_pk_add_f32 v[82:83], v[26:27], v[34:35] neg_lo:[0,1] neg_hi:[0,1]
    v_pk_add_f32 v[104:105], v[28:29], v[36:37]
    v_pk_add_f32 v[106:107], v[30:31], v[38:39]
    v_pk_add_f32 v[96:97], v[28:29], v[36:37] neg_lo:[0,1] neg_hi:[0,1]
    v_pk_add_f32 v[98:99], v[30:31], v[38:39] neg_lo:[0,1] neg_hi:[0,1]
    ds_write_b128 v166, v[76:79] offset:6144
    v_pk_add_f32 v[88:89], v[88:89], v[16:17] neg_lo:[0,1] neg_hi:[0,1]
    v_pk_add_f32 v[90:91], v[90:91], v[18:19] neg_lo:[0,1] neg_hi:[0,1]
    v_pk_add_f32 v[80:81], v[80:81], v[40:41] neg_lo:[0,1] neg_hi:[0,1]
    v_pk_add_f32 v[82:83], v[82:83], v[42:43] neg_lo:[0,1] neg_hi:[0,1]
    v_pk_add_f32 v[104:105], v[104:105], v[20:21] neg_lo:[0,1] neg_hi:[0,1]
    v_pk_add_f32 v[106:107], v[106:107], v[22:23] neg_lo:[0,1] neg_hi:[0,1]
    v_pk_add_f32 v[96:97], v[96:97], v[44:45] neg_lo:[0,1] neg_hi:[0,1]
    v_pk_add_f32 v[98:99], v[98:99], v[46:47] neg_lo:[0,1] neg_hi:[0,1]
    v_pk_add_f32 v[88:89], v[88:89], v[20:21]
    v_pk_add_f32 v[90:91], v[90:91], v[22:23]
    v_pk_add_f32 v[96:97], v[96:97], v[40:41]
    v_pk_add_f32 v[98:99], v[98:99], v[42:43]
    v_add_f32_dpp v80, v44, v80 row_shr:1 row_mask:0xf bank_mask:0xf bound_ctrl:1
    v_add_f32_dpp v81, v45, v81 row_shr:1 row_mask:0xf bank_mask:0xf bound_ctrl:1
    v_add_f32_dpp v82, v46, v82 row_shr:1 row_mask:0xf bank_mask:0xf bound_ctrl:1
    v_add_f32_dpp v83, v47, v83 row_shr:1 row_mask:0xf bank_mask:0xf bound_ctrl:1
    v_add_f32_dpp v104, v16, v104 row_shl:1 row_mask:0xf bank_mask:0xf bound_ctrl:1
    v_add_f32_dpp v105, v17, v105 row_shl:1 row_mask:0xf bank_mask:0xf bound_ctrl:1
    v_add_f32_dpp v106, v18, v106 row_shl:1 row_mask:0xf bank_mask:0xf bound_ctrl:1
    v_add_f32_dpp v107, v19, v107 row_shl:1 row_mask:0xf bank_mask:0xf bound_ctrl:1
    s_waitcnt vmcnt(0)
    v_pk_mul_f32 v[208:209], v[208:209], s[52:53] op_sel_hi:[1,0]
    v_pk_mul_f32 v[210:211], v[210:211], s[52:53] op_sel_hi:[1,0]
    v_pk_mul_f32 v[212:213], v[212:213], s[52:53] op_sel_hi:[1,0]
    v_pk_mul_f32 v[214:215], v[214:215], s[52:53] op_sel_hi:[1,0]
    s_waitcnt lgkmcnt(0)
    s_barrier
    s_nop 0
    ds_read_b128 v[112:115], v167 offset:0
    ds_read_b128 v[128:131], v167 offset:8192
    ds_read_b128 v[176:179], v167 offset:16384
    v_accvgpr_read_b32 v24, a40
    v_accvgpr_read_b32 v25, a41
    v_accvgpr_read_b32 v26, a42
    v_accvgpr_read_b32 v27, a43
    v_accvgpr_read_b32 v32, a48
    v_accvgpr_read_b32 v33, a49
    v_accvgpr_read_b32 v34, a50
    v_accvgpr_read_b32 v35, a51
    v_accvgpr_read_b32 v28, a44
    v_accvgpr_read_b32 v29, a45
    ds_read_b128 v[116:119], v167 offset:2048
    ds_read_b128 v[132:135], v167 offset:10240
    ds_read_b128 v[184:187], v167 offset:18432
    v_accvgpr_read_b32 v30, a46
    v_accvgpr_read_b32 v31, a47
    v_accvgpr_read_b32 v36, a52
    v_accvgpr_read_b32 v37, a53
    v_accvgpr_read_b32 v38, a54
    v_accvgpr_read_b32 v39, a55
    v_accvgpr_read_b32 v16, a32
    v_accvgpr_read_b32 v17, a33
    v_accvgpr_read_b32 v18, a34
    v_accvgpr_read_b32 v19, a35
    ds_read_b128 v[120:123], v167 offset:4096
    ds_read_b128 v[136:139], v167 offset:12288
    ds_read_b128 v[192:195], v167 offset:20480
    v_accvgpr_read_b32 v20, a36
    v_accvgpr_read_b32 v21, a37
    v_accvgpr_read_b32 v22, a38
    v_accvgpr_read_b32 v23, a39
    v_accvgpr_read_b32 v40, a56
    v_accvgpr_read_b32 v41, a57
    v_accvgpr_read_b32 v42, a58
    v_accvgpr_read_b32 v43, a59
    v_accvgpr_read_b32 v44, a60
    v_accvgpr_read_b32 v45, a61
    ds_read_b128 v[124:127], v167 offset:6144
    ds_read_b128 v[140:143], v167 offset:14336
    ds_read_b128 v[200:203], v167 offset:22528
    v_accvgpr_read_b32 v46, a62
    v_accvgpr_read_b32 v47, a63
    v_pk_add_f32 v[52:53], v[24:25], v[32:33]
    v_pk_add_f32 v[54:55], v[26:27], v[34:35]
    v_pk_add_f32 v[48:49], v[24:25], v[32:33] neg_lo:[0,1] neg_hi:[0,1]
    v_pk_add_f32 v[50:51], v[26:27], v[34:35] neg_lo:[0,1] neg_hi:[0,1]
    v_pk_add_f32 v[60:61], v[28:29], v[36:37]
    v_pk_add_f32 v[62:63], v[30:31], v[38:39]
    v_pk_add_f32 v[56:57], v[28:29], v[36:37] neg_lo:[0,1] neg_hi:[0,1]
    v_pk_add_f32 v[58:59], v[30:31], v[38:39] neg_lo:[0,1] neg_hi:[0,1]
    v_pk_add_f32 v[52:53], v[52:53], v[16:17] neg_lo:[0,1] neg_hi:[0,1]
    v_pk_add_f32 v[54:55], v[54:55], v[18:19] neg_lo:[0,1] neg_hi:[0,1]
    v_pk_add_f32 v[48:49], v[48:49], v[40:41] neg_lo:[0,1] neg_hi:[0,1]
    v_pk_add_f32 v[50:51], v[50:51], v[42:43] neg_lo:[0,1] neg_hi:[0,1]
    v_pk_add_f32 v[60:61], v[60:61], v[20:21] neg_lo:[0,1] neg_hi:[0,1]
    v_pk_add_f32 v[62:63], v[62:63], v[22:23] neg_lo:[0,1] neg_hi:[0,1]
    v_pk_add_f32 v[56:57], v[56:57], v[44:45] neg_lo:[0,1] neg_hi:[0,1]
    v_pk_add_f32 v[58:59], v[58:59], v[46:47] neg_lo:[0,1] neg_hi:[0,1]
    v_pk_add_f32 v[52:53], v[52:53], v[20:21]
    v_pk_add_f32 v[54:55], v[54:55], v[22:23]
    v_pk_add_f32 v[56:57], v[56:57], v[40:41]
    v_pk_add_f32 v[58:59], v[58:59], v[42:43]
    v_add_f32_dpp v48, v44, v48 row_shr:1 row_mask:0xf bank_mask:0xf bound_ctrl:1
    v_add_f32_dpp v49, v45, v49 row_shr:1 row_mask:0xf bank_mask:0xf bound_ctrl:1
    v_add_f32_dpp v50, v46, v50 row_shr:1 row_mask:0xf bank_mask:0xf bound_ctrl:1
    v_add_f32_dpp v51, v47, v51 row_shr:1 row_mask:0xf bank_mask:0xf bound_ctrl:1
    v_add_f32_dpp v60, v16, v60 row_shl:1 row_mask:0xf bank_mask:0xf bound_ctrl:1
    v_add_f32_dpp v61, v17, v61 row_shl:1 row_mask:0xf bank_mask:0xf bound_ctrl:1
    v_add_f32_dpp v62, v18, v62 row_shl:1 row_mask:0xf bank_mask:0xf bound_ctrl:1
    v_add_f32_dpp v63, v19, v63 row_shl:1 row_mask:0xf bank_mask:0xf bound_ctrl:1
    s_waitcnt lgkmcnt(6)
    s_nop 0
    v_pk_fma_f32 v[176:177], v[80:81], s[56:57], v[176:177] op_sel:[0,1,0]
    v_pk_fma_f32 v[178:179], v[82:83], s[56:57], v[178:179] op_sel:[0,1,0]
    v_pk_fma_f32 v[184:185], v[88:89], s[56:57], v[184:185] op_sel:[0,1,0]
    v_pk_fma_f32 v[186:187], v[90:91], s[56:57], v[186:187] op_sel:[0,1,0]
    v_pk_add_f32 v[80:81], v[80:81], v[112:113]
    v_pk_add_f32 v[82:83], v[82:83], v[114:115]
    v_pk_add_f32 v[88:89], v[88:89], v[116:117]
    v_pk_add_f32 v[90:91], v[90:91], v[118:119]
    v_pk_fma_f32 v[176:177], v[128:129], s[54:55], v[176:177] op_sel:[0,1,0]
    v_pk_fma_f32 v[178:179], v[130:131], s[54:55], v[178:179] op_sel:[0,1,0]
    v_pk_fma_f32 v[184:185], v[132:133], s[54:55], v[184:185] op_sel:[0,1,0]
    v_pk_fma_f32 v[186:187], v[134:135], s[54:55], v[186:187] op_sel:[0,1,0]
    v_pk_fma_f32 v[80:81], v[128:129], s[54:55], v[80:81] op_sel_hi:[1,0,1]
    v_pk_fma_f32 v[82:83], v[130:131], s[54:55], v[82:83] op_sel_hi:[1,0,1]
    v_pk_fma_f32 v[88:89], v[132:133], s[54:55], v[88:89] op_sel_hi:[1,0,1]
    v_pk_fma_f32 v[90:91], v[134:135], s[54:55], v[90:91] op_sel_hi:[1,0,1]
    v_pk_fma_f32 v[176:177], v[112:113], s[56:57], v[176:177] op_sel_hi:[1,0,1]
    v_pk_fma_f32 v[178:179], v[114:115], s[56:57], v[178:179] op_sel_hi:[1,0,1]
    v_pk_fma_f32 v[184:185], v[116:117], s[56:57], v[184:185] op_sel_hi:[1,0,1]
    v_pk_fma_f32 v[186:187], v[118:119], s[56:57], v[186:187] op_sel_hi:[1,0,1]
    s_waitcnt lgkmcnt(0)
    s_nop 0
    v_pk_fma_f32 v[192:193], v[96:97], s[56:57], v[192:193] op_sel:[0,1,0]
    v_pk_fma_f32 v[194:195], v[98:99], s[56:57], v[194:195] op_sel:[0,1,0]
    v_pk_fma_f32 v[200:201], v[104:105], s[56:57], v[200:201] op_sel:[0,1,0]
    v_pk_fma_f32 v[202:203], v[106:107], s[56:57], v[202:203] op_sel:[0,1,0]
    v_pk_add_f32 v[96:97], v[96:97], v[120:121]
    v_pk_add_f32 v[98:99], v[98:99], v[122:123]
    v_pk_add_f32 v[104:105], v[104:105], v[124:125]
    v_pk_add_f32 v[106:107], v[106:107], v[126:127]
    v_pk_fma_f32 v[192:193], v[136:137], s[54:55], v[192:193] op_sel:[0,1,0]
    v_pk_fma_f32 v[194:195], v[138:139], s[54:55], v[194:195] op_sel:[0,1,0]
    v_pk_fma_f32 v[200:201], v[140:141], s[54:55], v[200:201] op_sel:[0,1,0]
    v_pk_fma_f32 v[202:203], v[142:143], s[54:55], v[202:203] op_sel:[0,1,0]
    v_pk_fma_f32 v[96:97], v[136:137], s[54:55], v[96:97] op_sel_hi:[1,0,1]
    v_pk_fma_f32 v[98:99], v[138:139], s[54:55], v[98:99] op_sel_hi:[1,0,1]
    v_pk_fma_f32 v[104:105], v[140:141], s[54:55], v[104:105] op_sel_hi:[1,0,1]
    v_pk_fma_f32 v[106:107], v[142:143], s[54:55], v[106:107] op_sel_hi:[1,0,1]
    v_pk_fma_f32 v[192:193], v[120:121], s[56:57], v[192:193] op_sel_hi:[1,0,1]
    v_pk_fma_f32 v[194:195], v[122:123], s[56:57], v[194:195] op_sel_hi:[1,0,1]
    v_pk_fma_f32 v[200:201], v[124:125], s[56:57], v[200:201] op_sel_hi:[1,0,1]
    v_pk_fma_f32 v[202:203], v[126:127], s[56:57], v[202:203] op_sel_hi:[1,0,1]
    v_lshlrev_b32 v16, 16, v224
    v_and_b32 v18, s88, v224
    v_lshlrev_b32 v20, 16, v225
    v_and_b32 v22, s88, v225
    v_lshlrev_b32 v17, 16, v226
    v_and_b32 v19, s88, v226
    v_lshlrev_b32 v21, 16, v227
    v_and_b32 v23, s88, v227
    v_pk_fma_f32 v[16:17], v[80:81], v[208:209], v[16:17]
    v_pk_fma_f32 v[18:19], v[88:89], v[208:209], v[18:19]
    v_pk_fma_f32 v[20:21], v[96:97], v[208:209], v[20:21]
    v_pk_fma_f32 v[22:23], v[104:105], v[208:209], v[22:23]
    v_cvt_pk_bf16_f32 v224, v16, v18
    v_cvt_pk_bf16_f32 v225, v20, v22
    v_cvt_pk_bf16_f32 v226, v17, v19
    v_cvt_pk_bf16_f32 v227, v21, v23
    buffer_store_dwordx2 v[224:225], v10, s[12:15], s60 offen sc1
    ds_write_b128 v164, v[52:55] offset:3072
    buffer_store_dwordx2 v[226:227], v10, s[12:15], s61 offen sc1
    v_lshlrev_b32 v24, 16, v240
    v_and_b32 v26, s88, v240
    v_lshlrev_b32 v28, 16, v241
    v_and_b32 v30, s88, v241
    v_lshlrev_b32 v25, 16, v242
    v_and_b32 v27, s88, v242
    v_lshlrev_b32 v29, 16, v243
    v_and_b32 v31, s88, v243
    v_pk_fma_f32 v[24:25], v[176:177], v[208:209], v[24:25]
    v_pk_fma_f32 v[26:27], v[184:185], v[208:209], v[26:27]
    v_pk_fma_f32 v[28:29], v[192:193], v[208:209], v[28:29]
    v_pk_fma_f32 v[30:31], v[200:201], v[208:209], v[30:31]
    v_cvt_pk_bf16_f32 v240, v24, v26
    v_cvt_pk_bf16_f32 v241, v28, v30
    v_cvt_pk_bf16_f32 v242, v25, v27
    ds_write_b128 v164, v[56:59] offset:5120
    v_cvt_pk_bf16_f32 v243, v29, v31
    v_lshlrev_b32 v32, 16, v228
    v_and_b32 v34, s88, v228
    v_lshlrev_b32 v36, 16, v229
    v_and_b32 v38, s88, v229
    v_lshlrev_b32 v33, 16, v230
    v_and_b32 v35, s88, v230
    v_lshlrev_b32 v37, 16, v231
    v_and_b32 v39, s88, v231
    v_pk_fma_f32 v[32:33], v[82:83], v[210:211], v[32:33]
    v_pk_fma_f32 v[34:35], v[90:91], v[210:211], v[34:35]
    v_pk_fma_f32 v[36:37], v[98:99], v[210:211], v[36:37]
    v_pk_fma_f32 v[38:39], v[106:107], v[210:211], v[38:39]
    v_cvt_pk_bf16_f32 v228, v32, v34
    v_cvt_pk_bf16_f32 v229, v36, v38
    v_cvt_pk_bf16_f32 v230, v33, v35
    v_cvt_pk_bf16_f32 v231, v37, v39
    ds_write_b128 v164, v[48:51] offset:1024
    v_lshlrev_b32 v40, 16, v244
    v_and_b32 v42, s88, v244
    v_lshlrev_b32 v44, 16, v245
    v_and_b32 v46, s88, v245
    v_lshlrev_b32 v41, 16, v246
    v_and_b32 v43, s88, v246
    v_lshlrev_b32 v45, 16, v247
    v_and_b32 v47, s88, v247
    v_pk_fma_f32 v[40:41], v[178:179], v[210:211], v[40:41]
    v_pk_fma_f32 v[42:43], v[186:187], v[210:211], v[42:43]
    v_pk_fma_f32 v[44:45], v[194:195], v[210:211], v[44:45]
    v_pk_fma_f32 v[46:47], v[202:203], v[210:211], v[46:47]
    v_cvt_pk_bf16_f32 v244, v40, v42
    v_cvt_pk_bf16_f32 v245, v44, v46
    v_cvt_pk_bf16_f32 v246, v41, v43
    v_cvt_pk_bf16_f32 v247, v45, v47
    ds_write_b128 v164, v[60:63] offset:7168
    v_accvgpr_read_b32 v24, a104
    v_accvgpr_read_b32 v25, a105
    v_accvgpr_read_b32 v26, a106
    buffer_store_dwordx2 v[240:241], v11, s[12:15], s60 offen sc1
    v_accvgpr_read_b32 v27, a107
    v_accvgpr_read_b32 v32, a112
    v_accvgpr_read_b32 v33, a113
    v_accvgpr_read_b32 v34, a114
    v_accvgpr_read_b32 v35, a115
    v_accvgpr_read_b32 v28, a108
    v_accvgpr_read_b32 v29, a109
    v_accvgpr_read_b32 v30, a110
    v_accvgpr_read_b32 v31, a111
    v_accvgpr_read_b32 v36, a116
    buffer_store_dwordx2 v[242:243], v11, s[12:15], s61 offen sc1
    v_accvgpr_read_b32 v37, a117
    v_accvgpr_read_b32 v38, a118
    v_accvgpr_read_b32 v39, a119
    v_accvgpr_read_b32 v16, a96
    v_accvgpr_read_b32 v17, a97
    v_accvgpr_read_b32 v18, a98
    v_accvgpr_read_b32 v19, a99
    v_accvgpr_read_b32 v20, a100
    v_accvgpr_read_b32 v21, a101
    v_accvgpr_read_b32 v22, a102
    buffer_store_dwordx2 v[228:229], v10, s[12:15], s62 offen sc1
    v_accvgpr_read_b32 v23, a103
    v_accvgpr_read_b32 v40, a120
    v_accvgpr_read_b32 v41, a121
    v_accvgpr_read_b32 v42, a122
    v_accvgpr_read_b32 v43, a123
    v_accvgpr_read_b32 v44, a124
    v_accvgpr_read_b32 v45, a125
    v_accvgpr_read_b32 v46, a126
    v_accvgpr_read_b32 v47, a127
    v_pk_add_f32 v[68:69], v[24:25], v[32:33]
    buffer_store_dwordx2 v[230:231], v10, s[12:15], s63 offen sc1
    v_pk_add_f32 v[70:71], v[26:27], v[34:35]
    v_pk_add_f32 v[64:65], v[24:25], v[32:33] neg_lo:[0,1] neg_hi:[0,1]
    v_pk_add_f32 v[66:67], v[26:27], v[34:35] neg_lo:[0,1] neg_hi:[0,1]
    v_pk_add_f32 v[76:77], v[28:29], v[36:37]
L_pad3:
    s_cbranch_execz L_back
    s_nop 0
    v_pk_add_f32 v[78:79], v[30:31], v[38:39]
    v_pk_add_f32 v[72:73], v[28:29], v[36:37] neg_lo:[0,1] neg_hi:[0,1]
    v_pk_add_f32 v[74:75], v[30:31], v[38:39] neg_lo:[0,1] neg_hi:[0,1]
    v_pk_add_f32 v[68:69], v[68:69], v[16:17] neg_lo:[0,1] neg_hi:[0,1]
    v_pk_add_f32 v[70:71], v[70:71], v[18:19] neg_lo:[0,1] neg_hi:[0,1]
    v_pk_add_f32 v[64:65], v[64:65], v[40:41] neg_lo:[0,1] neg_hi:[0,1]
    buffer_store_dwordx2 v[244:245], v11, s[12:15], s62 offen sc1
    v_pk_add_f32 v[66:67], v[66:67], v[42:43] neg_lo:[0,1] neg_hi:[0,1]
    v_pk_add_f32 v[76:77], v[76:77], v[20:21] neg_lo:[0,1] neg_hi:[0,1]
    v_pk_add_f32 v[78:79], v[78:79], v[22:23] neg_lo:[0,1] neg_hi:[0,1]
    v_pk_add_f32 v[72:73], v[72:73], v[44:45] neg_lo:[0,1] neg_hi:[0,1]
    v_pk_add_f32 v[74:75], v[74:75], v[46:47] neg_lo:[0,1] neg_hi:[0,1]
    v_pk_add_f32 v[68:69], v[68:69], v[20:21]
    v_pk_add_f32 v[70:71], v[70:71], v[22:23]
    v_pk_add_f32 v[72:73], v[72:73], v[40:41]
    v_pk_add_f32 v[74:75], v[74:75], v[42:43]
    v_add_f32_dpp v64, v44, v64 row_shr:1 row_mask:0xf bank_mask:0xf bound_ctrl:1
    buffer_store_dwordx2 v[246:247], v11, s[12:15], s63 offen sc1
    v_add_f32_dpp v65, v45, v65 row_shr:1 row_mask:0xf bank_mask:0xf bound_ctrl:1
    v_add_f32_dpp v66, v46, v66 row_shr:1 row_mask:0xf bank_mask:0xf bound_ctrl:1
    v_add_f32_dpp v67, v47, v67 row_shr:1 row_mask:0xf bank_mask:0xf bound_ctrl:1
    v_add_f32_dpp v76, v16, v76 row_shl:1 row_mask:0xf bank_mask:0xf bound_ctrl:1
    v_add_f32_dpp v77, v17, v77 row_shl:1 row_mask:0xf bank_mask:0xf bound_ctrl:1
    v_add_f32_dpp v78, v18, v78 row_shl:1 row_mask:0xf bank_mask:0xf bound_ctrl:1
    v_add_f32_dpp v79, v19, v79 row_shl:1 row_mask:0xf bank_mask:0xf bound_ctrl:1
    v_accvgpr_read_b32 v24, a168
    v_accvgpr_read_b32 v25, a169
    v_accvgpr_read_b32 v26, a170
    v_accvgpr_read_b32 v27, a171
    v_accvgpr_read_b32 v32, a176
    v_accvgpr_read_b32 v33, a177
    v_accvgpr_read_b32 v34, a178
    v_accvgpr_read_b32 v35, a179
    v_accvgpr_read_b32 v28, a172
    v_accvgpr_read_b32 v29, a173
    v_accvgpr_read_b32 v30, a174
    v_accvgpr_read_b32 v31, a175
    v_accvgpr_read_b32 v36, a180
    v_accvgpr_read_b32 v37, a181
    v_accvgpr_read_b32 v38, a182
    ds_write_b128 v165, v[68:71] offset:3072
    v_accvgpr_read_b32 v39, a183
    v_accvgpr_read_b32 v16, a160
    v_accvgpr_read_b32 v17, a161
    v_accvgpr_read_b32 v18, a162
    v_accvgpr_read_b32 v19, a163
    v_accvgpr_read_b32 v20, a164
    v_accvgpr_read_b32 v21, a165
    v_accvgpr_read_b32 v22, a166
    v_accvgpr_read_b32 v23, a167
    v_accvgpr_read_b32 v40, a184
    v_accvgpr_read_b32 v41, a185
    v_accvgpr_read_b32 v42, a186
    v_accvgpr_read_b32 v43, a187
    v_accvgpr_read_b32 v44, a188
    v_accvgpr_read_b32 v45, a189
    ds_write_b128 v165, v[72:75] offset:5120
    v_accvgpr_read_b32 v46, a190
    v_accvgpr_read_b32 v47, a191
    v_pk_add_f32 v[52:53], v[24:25], v[32:33]
    v_pk_add_f32 v[54:55], v[26:27], v[34:35]
    v_pk_add_f32 v[48:49], v[24:25], v[32:33] neg_lo:[0,1] neg_hi:[0,1]
    v_pk_add_f32 v[50:51], v[26:27], v[34:35] neg_lo:[0,1] neg_hi:[0,1]
    v_pk_add_f32 v[60:61], v[28:29], v[36:37]
    v_pk_add_f32 v[62:63], v[30:31], v[38:39]
    v_pk_add_f32 v[56:57], v[28:29], v[36:37] neg_lo:[0,1] neg_hi:[0,1]
    v_pk_add_f32 v[58:59], v[30:31], v[38:39] neg_lo:[0,1] neg_hi:[0,1]
    v_pk_add_f32 v[52:53], v[52:53], v[16:17] neg_lo:[0,1] neg_hi:[0,1]
    v_pk_add_f32 v[54:55], v[54:55], v[18:19] neg_lo:[0,1] neg_hi:[0,1]
    v_pk_add_f32 v[48:49], v[48:49], v[40:41] neg_lo:[0,1] neg_hi:[0,1]
    v_pk_add_f32 v[50:51], v[50:51], v[42:43] neg_lo:[0,1] neg_hi:[0,1]
    v_pk_add_f32 v[60:61], v[60:61], v[20:21] neg_lo:[0,1] neg_hi:[0,1]
    ds_write_b128 v165, v[64:67] offset:1024
    v_pk_add_f32 v[62:63], v[62:63], v[22:23] neg_lo:[0,1] neg_hi:[0,1]
    v_pk_add_f32 v[56:57], v[56:57], v[44:45] neg_lo:[0,1] neg_hi:[0,1]
    v_pk_add_f32 v[58:59], v[58:59], v[46:47] neg_lo:[0,1] neg_hi:[0,1]
    v_pk_add_f32 v[52:53], v[52:53], v[20:21]
    v_pk_add_f32 v[54:55], v[54:55], v[22:23]
    v_pk_add_f32 v[56:57], v[56:57], v[40:41]
    v_pk_add_f32 v[58:59], v[58:59], v[42:43]
    v_add_f32_dpp v48, v44, v48 row_shr:1 row_mask:0xf bank_mask:0xf bound_ctrl:1
    v_add_f32_dpp v49, v45, v49 row_shr:1 row_mask:0xf bank_mask:0xf bound_ctrl:1
    v_add_f32_dpp v50, v46, v50 row_shr:1 row_mask:0xf bank_mask:0xf bound_ctrl:1
    v_add_f32_dpp v51, v47, v51 row_shr:1 row_mask:0xf bank_mask:0xf bound_ctrl:1
    v_add_f32_dpp v60, v16, v60 row_shl:1 row_mask:0xf bank_mask:0xf bound_ctrl:1
    v_add_f32_dpp v61, v17, v61 row_shl:1 row_mask:0xf bank_mask:0xf bound_ctrl:1
    v_add_f32_dpp v62, v18, v62 row_shl:1 row_mask:0xf bank_mask:0xf bound_ctrl:1
    v_add_f32_dpp v63, v19, v63 row_shl:1 row_mask:0xf bank_mask:0xf bound_ctrl:1
    ds_write_b128 v165, v[76:79] offset:7168
    v_accvgpr_read_b32 v24, a232
    v_accvgpr_read_b32 v25, a233
    v_accvgpr_read_b32 v26, a234
    v_accvgpr_read_b32 v27, a235
    v_accvgpr_read_b32 v32, a240
    v_accvgpr_read_b32 v33, a241
    v_accvgpr_read_b32 v34, a242
    v_accvgpr_read_b32 v35, a243
    v_accvgpr_read_b32 v28, a236
    v_accvgpr_read_b32 v29, a237
    ds_write_b128 v166, v[52:55] offset:3072
    v_accvgpr_read_b32 v30, a238
    v_accvgpr_read_b32 v31, a239
    v_accvgpr_read_b32 v36, a244
    v_accvgpr_read_b32 v37, a245
    v_accvgpr_read_b32 v38, a246
    v_accvgpr_read_b32 v39, a247
    v_accvgpr_read_b32 v16, a224
    v_accvgpr_read_b32 v17, a225
    v_accvgpr_read_b32 v18, a226
    v_accvgpr_read_b32 v19, a227
    ds_write_b128 v166, v[56:59] offset:5120
    v_accvgpr_read_b32 v20, a228
    v_accvgpr_read_b32 v21, a229
    v_accvgpr_read_b32 v22, a230
    v_accvgpr_read_b32 v23, a231
    v_accvgpr_read_b32 v40, a248
    v_accvgpr_read_b32 v41, a249
    v_accvgpr_read_b32 v42, a250
    v_accvgpr_read_b32 v43, a251
    v_accvgpr_read_b32 v44, a252
    v_accvgpr_read_b32 v45, a253
    ds_write_b128 v166, v[48:51] offset:1024
    v_accvgpr_read_b32 v46, a254
    v_accvgpr_read_b32 v47, a255
    v_pk_add_f32 v[92:93], v[24:25], v[32:33]
    v_pk_add_f32 v[94:95], v[26:27], v[34:35]
    v_pk_add_f32 v[84:85], v[24:25], v[32:33] neg_lo:[0,1] neg_hi:[0,1]
    v_pk_add_f32 v[86:87], v[26:27], v[34:35] neg_lo:[0,1] neg_hi:[0,1]
    v_pk_add_f32 v[108:109], v[28:29], v[36:37]
    v_pk_add_f32 v[110:111], v[30:31], v[38:39]
    v_pk_add_f32 v[100:101], v[28:29], v[36:37] neg_lo:[0,1] neg_hi:[0,1]
    v_pk_add_f32 v[102:103], v[30:31], v[38:39] neg_lo:[0,1] neg_hi:[0,1]
    ds_write_b128 v166, v[60:63] offset:7168
    v_pk_add_f32 v[92:93], v[92:93], v[16:17] neg_lo:[0,1] neg_hi:[0,1]
    v_pk_add_f32 v[94:95], v[94:95], v[18:19] neg_lo:[0,1] neg_hi:[0,1]
    v_pk_add_f32 v[84:85], v[84:85], v[40:41] neg_lo:[0,1] neg_hi:[0,1]
    v_pk_add_f32 v[86:87], v[86:87], v[42:43] neg_lo:[0,1] neg_hi:[0,1]
    v_pk_add_f32 v[108:109], v[108:109], v[20:21] neg_lo:[0,1] neg_hi:[0,1]
    v_pk_add_f32 v[110:111], v[110:111], v[22:23] neg_lo:[0,1] neg_hi:[0,1]
    v_pk_add_f32 v[100:101], v[100:101], v[44:45] neg_lo:[0,1] neg_hi:[0,1]
    v_pk_add_f32 v[102:103], v[102:103], v[46:47] neg_lo:[0,1] neg_hi:[0,1]
    v_pk_add_f32 v[92:93], v[92:93], v[20:21]
    v_pk_add_f32 v[94:95], v[94:95], v[22:23]
    v_pk_add_f32 v[100:101], v[100:101], v[40:41]
    v_pk_add_f32 v[102:103], v[102:103], v[42:43]
    v_add_f32_dpp v84, v44, v84 row_shr:1 row_mask:0xf bank_mask:0xf bound_ctrl:1
    v_add_f32_dpp v85, v45, v85 row_shr:1 row_mask:0xf bank_mask:0xf bound_ctrl:1
    v_add_f32_dpp v86, v46, v86 row_shr:1 row_mask:0xf bank_mask:0xf bound_ctrl:1
    v_add_f32_dpp v87, v47, v87 row_shr:1 row_mask:0xf bank_mask:0xf bound_ctrl:1
    v_add_f32_dpp v108, v16, v108 row_shl:1 row_mask:0xf bank_mask:0xf bound_ctrl:1
    v_add_f32_dpp v109, v17, v109 row_shl:1 row_mask:0xf bank_mask:0xf bound_ctrl:1
    v_add_f32_dpp v110, v18, v110 row_shl:1 row_mask:0xf bank_mask:0xf bound_ctrl:1
    v_add_f32_dpp v111, v19, v111 row_shl:1 row_mask:0xf bank_mask:0xf bound_ctrl:1
    s_waitcnt lgkmcnt(0)
    s_barrier
    ds_read_b128 v[112:115], v167 offset:1024
    ds_read_b128 v[128:131], v167 offset:9216
    ds_read_b128 v[180:183], v167 offset:17408
    v_lshlrev_b32 v16, 16, v232
    v_and_b32 v18, s88, v232
    v_lshlrev_b32 v20, 16, v233
    v_and_b32 v22, s88, v233
    ds_read_b128 v[116:119], v167 offset:3072
    ds_read_b128 v[132:135], v167 offset:11264
    ds_read_b128 v[188:191], v167 offset:19456
    v_lshlrev_b32 v17, 16, v234
    v_and_b32 v19, s88, v234
    v_lshlrev_b32 v21, 16, v235
    v_and_b32 v23, s88, v235
    ds_read_b128 v[120:123], v167 offset:5120
    ds_read_b128 v[136:139], v167 offset:13312
    ds_read_b128 v[196:199], v167 offset:21504
    v_lshlrev_b32 v24, 16, v248
    v_and_b32 v26, s88, v248
    v_lshlrev_b32 v28, 16, v249
    v_and_b32 v30, s88, v249
    ds_read_b128 v[124:127], v167 offset:7168
    ds_read_b128 v[140:143], v167 offset:15360
    ds_read_b128 v[204:207], v167 offset:23552
    v_lshlrev_b32 v25, 16, v250
    v_and_b32 v27, s88, v250
    v_lshlrev_b32 v29, 16, v251
    v_and_b32 v31, s88, v251
    s_waitcnt lgkmcnt(0)
    s_nop 0
    v_pk_fma_f32 v[180:181], v[84:85], s[56:57], v[180:181] op_sel:[0,1,0]
    v_pk_fma_f32 v[188:189], v[92:93], s[56:57], v[188:189] op_sel:[0,1,0]
    v_pk_fma_f32 v[196:197], v[100:101], s[56:57], v[196:197] op_sel:[0,1,0]
    v_pk_fma_f32 v[204:205], v[108:109], s[56:57], v[204:205] op_sel:[0,1,0]
    v_pk_add_f32 v[84:85], v[84:85], v[112:113]
    v_pk_add_f32 v[92:93], v[92:93], v[116:117]
    v_pk_add_f32 v[100:101], v[100:101], v[120:121]
    v_pk_add_f32 v[108:109], v[108:109], v[124:125]
    v_pk_fma_f32 v[180:181], v[128:129], s[54:55], v[180:181] op_sel:[0,1,0]
    v_pk_fma_f32 v[188:189], v[132:133], s[54:55], v[188:189] op_sel:[0,1,0]
    v_pk_fma_f32 v[196:197], v[136:137], s[54:55], v[196:197] op_sel:[0,1,0]
    v_pk_fma_f32 v[204:205], v[140:141], s[54:55], v[204:205] op_sel:[0,1,0]
    v_pk_fma_f32 v[84:85], v[128:129], s[54:55], v[84:85] op_sel_hi:[1,0,1]
    v_pk_fma_f32 v[92:93], v[132:133], s[54:55], v[92:93] op_sel_hi:[1,0,1]
    v_pk_fma_f32 v[100:101], v[136:137], s[54:55], v[100:101] op_sel_hi:[1,0,1]
    v_pk_fma_f32 v[108:109], v[140:141], s[54:55], v[108:109] op_sel_hi:[1,0,1]
    v_pk_fma_f32 v[180:181], v[112:113], s[56:57], v[180:181] op_sel_hi:[1,0,1]
    v_pk_fma_f32 v[188:189], v[116:117], s[56:57], v[188:189] op_sel_hi:[1,0,1]
    v_pk_fma_f32 v[196:197], v[120:121], s[56:57], v[196:197] op_sel_hi:[1,0,1]
    v_pk_fma_f32 v[204:205], v[124:125], s[56:57], v[204:205] op_sel_hi:[1,0,1]
    v_pk_fma_f32 v[16:17], v[84:85], v[212:213], v[16:17]
    v_pk_fma_f32 v[18:19], v[92:93], v[212:213], v[18:19]
    v_pk_fma_f32 v[20:21], v[100:101], v[212:213], v[20:21]
    v_pk_fma_f32 v[22:23], v[108:109], v[212:213], v[22:23]
    v_cvt_pk_bf16_f32 v232, v16, v18
    v_cvt_pk_bf16_f32 v233, v20, v22
    v_cvt_pk_bf16_f32 v234, v17, v19
    v_cvt_pk_bf16_f32 v235, v21, v23
    buffer_store_dwordx2 v[232:233], v10, s[12:15], s64 offen sc1
    buffer_store_dwordx2 v[234:235], v10, s[12:15], s65 offen sc1
    v_pk_fma_f32 v[24:25], v[180:181], v[212:213], v[24:25]
    v_pk_fma_f32 v[26:27], v[188:189], v[212:213], v[26:27]
    v_pk_fma_f32 v[28:29], v[196:197], v[212:213], v[28:29]
    v_pk_fma_f32 v[30:31], v[204:205], v[212:213], v[30:31]
    v_cvt_pk_bf16_f32 v248, v24, v26
    v_cvt_pk_bf16_f32 v249, v28, v30
    v_cvt_pk_bf16_f32 v250, v25, v27
    v_cvt_pk_bf16_f32 v251, v29, v31
    buffer_store_dwordx2 v[248:249], v11, s[12:15], s64 offen sc1
    buffer_store_dwordx2 v[250:251], v11, s[12:15], s65 offen sc1
    v_lshlrev_b32 v32, 16, v236
    v_and_b32 v34, s88, v236
    v_lshlrev_b32 v36, 16, v237
    v_and_b32 v38, s88, v237
    v_lshlrev_b32 v33, 16, v238
    v_and_b32 v35, s88, v238
    v_lshlrev_b32 v37, 16, v239
    v_and_b32 v39, s88, v239
    v_lshlrev_b32 v40, 16, v252
    v_and_b32 v42, s88, v252
    v_lshlrev_b32 v44, 16, v253
    v_and_b32 v46, s88, v253
    v_lshlrev_b32 v41, 16, v254
    v_and_b32 v43, s88, v254
    v_lshlrev_b32 v45, 16, v255
    v_and_b32 v47, s88, v255
    v_pk_fma_f32 v[182:183], v[86:87], s[56:57], v[182:183] op_sel:[0,1,0]
    v_pk_fma_f32 v[190:191], v[94:95], s[56:57], v[190:191] op_sel:[0,1,0]
    v_pk_fma_f32 v[198:199], v[102:103], s[56:57], v[198:199] op_sel:[0,1,0]
    v_pk_fma_f32 v[206:207], v[110:111], s[56:57], v[206:207] op_sel:[0,1,0]
    v_pk_add_f32 v[86:87], v[86:87], v[114:115]
    v_pk_add_f32 v[94:95], v[94:95], v[118:119]
    v_pk_add_f32 v[102:103], v[102:103], v[122:123]
    v_pk_add_f32 v[110:111], v[110:111], v[126:127]
    v_pk_fma_f32 v[182:183], v[130:131], s[54:55], v[182:183] op_sel:[0,1,0]
    v_pk_fma_f32 v[190:191], v[134:135], s[54:55], v[190:191] op_sel:[0,1,0]
    v_pk_fma_f32 v[198:199], v[138:139], s[54:55], v[198:199] op_sel:[0,1,0]
    v_pk_fma_f32 v[206:207], v[142:143], s[54:55], v[206:207] op_sel:[0,1,0]
    v_pk_fma_f32 v[86:87], v[130:131], s[54:55], v[86:87] op_sel_hi:[1,0,1]
    v_pk_fma_f32 v[94:95], v[134:135], s[54:55], v[94:95] op_sel_hi:[1,0,1]
    v_pk_fma_f32 v[102:103], v[138:139], s[54:55], v[102:103] op_sel_hi:[1,0,1]
    v_pk_fma_f32 v[110:111], v[142:143], s[54:55], v[110:111] op_sel_hi:[1,0,1]
    v_pk_fma_f32 v[182:183], v[114:115], s[56:57], v[182:183] op_sel_hi:[1,0,1]
    v_pk_fma_f32 v[190:191], v[118:119], s[56:57], v[190:191] op_sel_hi:[1,0,1]
    v_pk_fma_f32 v[198:199], v[122:123], s[56:57], v[198:199] op_sel_hi:[1,0,1]
    v_pk_fma_f32 v[206:207], v[126:127], s[56:57], v[206:207] op_sel_hi:[1,0,1]
    v_pk_fma_f32 v[32:33], v[86:87], v[214:215], v[32:33]
    v_pk_fma_f32 v[34:35], v[94:95], v[214:215], v[34:35]
    v_pk_fma_f32 v[36:37], v[102:103], v[214:215], v[36:37]
    v_pk_fma_f32 v[38:39], v[110:111], v[214:215], v[38:39]
    v_cvt_pk_bf16_f32 v236, v32, v34
    v_cvt_pk_bf16_f32 v237, v36, v38
    v_cvt_pk_bf16_f32 v238, v33, v35
    v_cvt_pk_bf16_f32 v239, v37, v39
    buffer_store_dwordx2 v[236:237], v10, s[12:15], s66 offen sc1
    buffer_store_dwordx2 v[238:239], v10, s[12:15], s67 offen sc1
    v_pk_fma_f32 v[40:41], v[182:183], v[214:215], v[40:41]
    v_pk_fma_f32 v[42:43], v[190:191], v[214:215], v[42:43]
    v_pk_fma_f32 v[44:45], v[198:199], v[214:215], v[44:45]
    v_pk_fma_f32 v[46:47], v[206:207], v[214:215], v[46:47]
    v_cvt_pk_bf16_f32 v252, v40, v42
    v_cvt_pk_bf16_f32 v253, v44, v46
    v_cvt_pk_bf16_f32 v254, v41, v43
    v_cvt_pk_bf16_f32 v255, v45, v47
    buffer_store_dwordx2 v[252:253], v11, s[12:15], s66 offen sc1
    buffer_store_dwordx2 v[254:255], v11, s[12:15], s67 offen sc1
    s_xor_b32 s37, s3, 1
    s_or_b32 s37, s37, s33
    s_cmp_lg_u32 s37, 0
    s_cbranch_scc1 L_else8
    v_mov_b32 v4, 0
    v_mov_b32 v5, 0
    v_mov_b32 v6, 0
    v_mov_b32 v7, 0
    s_lshl_b32 s37, s32, 5
    v_mov_b32 v2, s37
    s_mov_b64 exec, 1
    global_store_dwordx4 v2, v[4:7], s[92:93] sc1
    s_mov_b64 exec, -1
L_else8:
L_end:
    s_endpgm
.fill 2100, 4, 0xbf810000
.section .rodata,"a"
.p2align 6
.amdhsa_kernel standalone__adm_resblock__diffusion_kernel
  .amdhsa_next_free_vgpr 512
  .amdhsa_next_free_sgpr 102
  .amdhsa_accum_offset 256
  .amdhsa_group_segment_fixed_size 0
  .amdhsa_kernarg_size 96
  .amdhsa_user_sgpr_count 2
  .amdhsa_user_sgpr_kernarg_segment_ptr 1
  .amdhsa_system_sgpr_workgroup_id_x 1
  .amdhsa_float_denorm_mode_32 3
.end_amdhsa_kernel
```
